```python
import torch

def _softmax(x, axis=-1):
    return torch.softmax(x, dim=axis)
def _gelu(x):
    return torch.nn.functional.gelu(x, approximate="tanh")
def _silu(x):
    return torch.nn.functional.silu(x)
def _sigmoid(x):
    return torch.sigmoid(x)
def _layernorm(x, axis=-1, eps=1e-5):
    m = x.mean(dim=axis, keepdim=True)
    v = x.var(dim=axis, keepdim=True, unbiased=False)
    return (x - m) / torch.sqrt(v + eps)
def _scatter_add(tgt, idx, src, axis=0):
    return tgt.clone().index_add_(axis, idx, src)
def _segment_sum(src, seg, n):
    out = torch.zeros((n,) + src.shape[1:], dtype=src.dtype)
    return out.index_add_(0, seg, src)
def _pad(x, pw):
    flat = tuple(v for pair in reversed(pw) for v in pair)
    return torch.nn.functional.pad(x, flat)

kernel_name = 'standalone__dense_activation_relu__prompt'

def setup_inputs():

    _w = (lambda a: (lambda t: t.to(torch.bfloat16) if t.is_floating_point() else t)(torch.as_tensor(a)))
    B, S, D, Dff = 1, 2048, 640, 1536
    return {
        "x": _w((lambda *s: torch.randn(*s, dtype=torch.bfloat16) * 0.05)(B, S, D)),
        "w1": _w((lambda *s: torch.randn(*s, dtype=torch.bfloat16) * 0.05)(D, Dff)),
        "w2": _w((lambda *s: torch.randn(*s, dtype=torch.bfloat16) * 0.05)(Dff, D)),
    }

def reference(x, w1, w2):
    h = torch.einsum("bsd,df->bsf", x, w1)
    zero = torch.zeros_like(h)
    h = torch.maximum(h, zero)
    return torch.einsum("bsf,fd->bsd", h, w2)
```

```asm
; @launch grid=(256,1,1) block=(256,1,1) lds=131072
.amdgcn_target "amdgcn-amd-amdhsa--gfx950"
.text
.globl standalone__dense_activation_relu__prompt_kernel
.p2align 8
.type standalone__dense_activation_relu__prompt_kernel,@function
standalone__dense_activation_relu__prompt_kernel:
    s_cmp_ge_u32 s2, 256
    s_cbranch_scc1 L_end
    s_load_dwordx2 s[8:9], s[0:1], 0
    s_load_dwordx2 s[12:13], s[0:1], 8
    s_load_dwordx2 s[16:17], s[0:1], 16
    s_load_dwordx2 s[20:21], s[0:1], 24
    s_load_dwordx2 s[24:25], s[0:1], 40
    s_lshr_b32 s30, s2, 3
    s_getpc_b64 s[72:73]
    s_lshl_b32 s39, s30, 9
    v_and_b32 v2, 0xc0, v0
    v_lshl_add_u32 v2, v2, 1, s39
    v_min_u32 v2, L_end-standalone__dense_activation_relu__prompt_kernel-64, v2
    global_load_dword v29, v2, s[72:73]
    v_lshrrev_b32 v2, 6, v0
    v_and_b32 v1, 63, v0
    s_and_b32 s29, s2, 7
    v_readfirstlane_b32 s28, v2
    s_mov_b32 s10, 2621440
    s_mov_b32 s11, 0x00020000
    s_mov_b32 s14, 1966080
    s_mov_b32 s15, 0x00020000
    s_mov_b32 s18, 1966080
    s_mov_b32 s19, 0x00020000
    v_lshrrev_b32 v2, 3, v1
    v_mul_u32_u24 v2, 1280, v2
    v_lshrrev_b32 v3, 4, v1
    v_and_b32 v4, 7, v1
    s_cmp_ge_u32 s30, 24
    s_cbranch_scc1 L_spare
    s_mul_i32 s31, s30, 43
    s_lshr_b32 s31, s31, 8
    s_mul_i32 s39, s31, 6
    s_sub_u32 s32, s30, s39
    s_lshr_b32 s39, s29, 1
    s_lshl_b32 s39, s39, 2
    s_add_u32 s33, s39, s31
    s_add_u32 s39, s32, s31
    s_lshl_b32 s40, s39, 2
    s_lshr_b32 s38, 0x30630630, s40
    s_and_b32 s38, s38, 15
    s_cmp_eq_u32 s39, 8
    s_cselect_b32 s38, 6, s38
    s_lshl_b32 s39, s33, 2
    s_add_u32 s39, s39, s28
    s_mul_i32 s36, s39, 40960
    s_lshl_b32 s44, s28, 12
    v_xor_b32 v4, v4, v3
    v_xor_b32 v5, 4, v4
    v_lshl_add_u32 v6, v4, 4, v2
    v_lshl_add_u32 v7, v5, 4, v2
    v_add_u32 v8, 18432, v6
    v_add_u32 v9, 27648, v7
    v_add_u32 v7, 9216, v7
    s_and_b32 s39, s29, 1
    s_mul_i32 s39, s39, 6
    s_add_u32 s34, s39, s32
    s_mul_i32 s37, s28, 49152
    s_lshl_b32 s39, s34, 8
    s_add_u32 s37, s37, s39
    v_bfe_u32 v4, v1, 1, 3
    v_xor_b32 v4, v4, v3
    v_mul_u32_u24 v5, 3072, v3
    v_and_b32 v11, 1, v1
    v_lshl_add_u32 v5, v11, 4, v5
    v_lshl_add_u32 v10, v4, 5, v5
    v_xor_b32 v4, 4, v4
    v_lshl_add_u32 v12, v4, 5, v5
    v_add_u32 v11, 11264, v10
    v_add_u32 v13, 33792, v12
    v_add_u32 v12, 22528, v12
    s_mov_b32 s41, 10375168
    s_lshl_b32 s42, s38, 7
    s_add_u32 s42, s42, s36
    s_mul_i32 s43, s38, 196608
    s_add_u32 s43, s43, s37
    s_add_u32 s72, s42, 128
    s_add_u32 s73, s43, 196608
    s_add_u32 s38, s38, 1
    s_waitcnt lgkmcnt(0)
    s_add_u32 m0, s44, 0
    s_nop 0
    buffer_load_dwordx4 v6, s[8:11], s42 offen offset:0 lds
    buffer_load_dwordx4 v7, s[8:11], s42 offen offset:1024 lds
    buffer_load_dwordx4 v8, s[8:11], s42 offen offset:2048 lds
    buffer_load_dwordx4 v9, s[8:11], s42 offen offset:3072 lds
    s_add_u32 m0, s44, 16384
    s_nop 0
    buffer_load_dwordx4 v10, s[12:15], s43 offen offset:0 lds
    buffer_load_dwordx4 v11, s[12:15], s43 offen offset:1024 lds
    buffer_load_dwordx4 v12, s[12:15], s43 offen offset:2048 lds
    buffer_load_dwordx4 v13, s[12:15], s43 offen offset:3072 lds
    s_add_u32 m0, s44, 32768
    s_nop 0
    buffer_load_dwordx4 v6, s[8:11], s72 offen offset:0 lds
    buffer_load_dwordx4 v7, s[8:11], s72 offen offset:1024 lds
    buffer_load_dwordx4 v8, s[8:11], s72 offen offset:2048 lds
    s_load_dword s96, s[24:25], s41
    s_add_u32 s38, s38, 1
    s_cmp_ge_u32 s38, 10
    s_cselect_b32 s38, 0, s38
    s_lshl_b32 s76, s38, 7
    s_add_u32 s76, s76, s36
    s_mul_i32 s77, s38, 196608
    s_add_u32 s77, s77, s37
    s_add_u32 s38, s38, 1
    s_cmp_ge_u32 s38, 10
    s_cselect_b32 s38, 0, s38
    s_lshl_b32 s78, s38, 7
    s_add_u32 s78, s78, s36
    s_mul_i32 s79, s38, 196608
    s_add_u32 s79, s79, s37
    s_add_u32 s38, s38, 1
    s_cmp_ge_u32 s38, 10
    s_cselect_b32 s38, 0, s38
    s_lshl_b32 s80, s38, 7
    s_add_u32 s80, s80, s36
    s_mul_i32 s81, s38, 196608
    s_add_u32 s81, s81, s37
    s_add_u32 s38, s38, 1
    s_cmp_ge_u32 s38, 10
    s_cselect_b32 s38, 0, s38
    s_lshl_b32 s82, s38, 7
    s_add_u32 s82, s82, s36
    s_mul_i32 s83, s38, 196608
    s_add_u32 s83, s83, s37
    s_add_u32 s38, s38, 1
    s_cmp_ge_u32 s38, 10
    s_cselect_b32 s38, 0, s38
    s_lshl_b32 s84, s38, 7
    s_add_u32 s84, s84, s36
    s_mul_i32 s85, s38, 196608
    s_add_u32 s85, s85, s37
    s_add_u32 s38, s38, 1
    s_cmp_ge_u32 s38, 10
    s_cselect_b32 s38, 0, s38
    s_lshl_b32 s86, s38, 7
    s_add_u32 s86, s86, s36
    s_mul_i32 s87, s38, 196608
    s_add_u32 s87, s87, s37
    s_add_u32 s38, s38, 1
    s_cmp_ge_u32 s38, 10
    s_cselect_b32 s38, 0, s38
    s_lshl_b32 s88, s38, 7
    s_add_u32 s88, s88, s36
    s_mul_i32 s89, s38, 196608
    s_add_u32 s89, s89, s37
    s_add_u32 s38, s38, 1
    s_cmp_ge_u32 s38, 10
    s_cselect_b32 s38, 0, s38
    s_lshl_b32 s90, s38, 7
    s_add_u32 s90, s90, s36
    s_mul_i32 s91, s38, 196608
    s_add_u32 s91, s91, s37
    v_and_b32 v2, 15, v1
    v_lshrrev_b32 v3, 4, v1
    v_bfe_u32 v4, v1, 1, 3
    v_xor_b32 v4, v4, v3
    s_lshr_b32 s39, s28, 1
    s_lshl_b32 s39, s39, 13
    v_lshlrev_b32 v5, 7, v2
    v_add_u32 v5, s39, v5
    v_lshl_add_u32 v14, v4, 4, v5
    v_xor_b32 v4, 4, v4
    v_lshl_add_u32 v15, v4, 4, v5
    v_bfe_u32 v4, v1, 2, 2
    v_lshl_add_u32 v5, v3, 3, v4
    v_lshlrev_b32 v5, 8, v5
    v_and_b32 v51, 3, v1
    v_lshl_add_u32 v5, v51, 3, v5
    v_add_u32 v5, 16384, v5
    v_bfe_u32 v4, v1, 2, 3
    s_and_b32 s39, s28, 1
    s_lshl_b32 s39, s39, 2
    v_xor_b32 v4, s39, v4
    v_xor_b32 v51, 0, v4
    v_lshl_add_u32 v16, v51, 5, v5
    v_xor_b32 v51, 1, v4
    v_lshl_add_u32 v17, v51, 5, v5
    v_xor_b32 v51, 2, v4
    v_lshl_add_u32 v18, v51, 5, v5
    v_xor_b32 v51, 3, v4
    v_lshl_add_u32 v19, v51, 5, v5
    v_add_u32 v20, 65536, v14
    v_add_u32 v21, 65536, v15
    v_add_u32 v22, 65536, v16
    v_add_u32 v23, 65536, v17
    v_add_u32 v24, 65536, v18
    v_add_u32 v25, 65536, v19
    s_lshr_b32 s39, s28, 1
    s_lshl_b32 s40, s33, 1
    s_add_u32 s39, s39, s40
    s_mul_i32 s60, s39, 24576
    s_lshl_b32 s40, s34, 11
    s_add_u32 s60, s60, s40
    s_and_b32 s40, s28, 1
    s_lshl_b32 s41, s40, 10
    s_add_u32 s60, s60, s41
    s_add_u32 s46, s60, 3145728
    v_lshlrev_b32 v31, 4, v1
    v_add_u32 v26, 786432, v31
    v_add_u32 v27, 1572864, v31
    v_add_u32 v61, 2359296, v31
    s_mul_i32 s41, s34, 86
    s_lshr_b32 s41, s41, 8
    s_lshl_b32 s39, s39, 9
    s_mul_i32 s48, s41, 104
    s_add_u32 s39, s39, s48
    s_lshl_b32 s48, s34, 3
    s_add_u32 s39, s39, s48
    s_lshl_b32 s40, s40, 2
    s_add_u32 s39, s39, s40
    s_add_u32 s39, s39, 10354688
    v_mov_b32 v32, s39
    s_mov_b32 s22, 2621440
    s_mov_b32 s23, 0x00020000
    s_mov_b32 s26, 268435456
    s_mov_b32 s27, 0x00020000
    v_mov_b32 v30, 0
    s_and_b32 s45, s30, 7
    s_lshr_b32 s39, s30, 3
    s_add_u32 s39, s39, s45
    s_add_u32 s39, s39, 1
    s_and_b32 s39, s39, 3
    s_lshl_b32 s35, s29, 2
    s_add_u32 s35, s35, s39
    v_lshlrev_b32 v41, 4, v1
    v_add_u32 v42, 49152, v41
    v_add_u32 v43, 98304, v41
    v_add_u32 v44, 147456, v41
    v_add_u32 v45, 196608, v41
    s_lshl_b32 s39, s35, 2
    s_add_u32 s39, s39, s28
    s_lshl_b32 s63, s39, 7
    s_add_u32 s63, s63, 10354688
    s_mul_i32 s39, s45, 5
    s_lshr_b32 s39, s39, 2
    s_lshl_b32 s39, s39, 9
    s_mul_i32 s40, s29, 5120
    s_add_u32 s39, s39, s40
    s_lshl_b32 s40, s28, 7
    s_add_u32 s39, s39, s40
    s_add_u32 s64, s39, 10485760
    v_and_b32 v4, 7, v1
    v_min_u32 v4, 5, v4
    v_bfe_u32 v5, v1, 3, 1
    v_lshlrev_b32 v5, 9, v5
    v_lshl_add_u32 v48, v4, 2, v5
    s_lshr_b32 s39, s45, 2
    s_lshl_b32 s39, s39, 1
    s_mul_i32 s40, s35, 24576
    s_mul_i32 s41, s28, 6144
    s_add_u32 s40, s40, s41
    s_mul_i32 s58, s45, 245760
    s_add_u32 s41, s41, s58
    s_add_u32 s41, s41, 8388608
    s_mul_i32 s39, s39, 1536
    s_xor_b32 s58, s39, 3072
    s_add_u32 s50, s39, s40
    s_add_u32 s54, s39, s41
    s_add_u32 s51, s58, s40
    s_add_u32 s55, s58, s41
    s_add_u32 s52, s50, 3145728
    s_add_u32 s56, s54, 24576
    s_add_u32 s53, s51, 3145728
    s_add_u32 s57, s55, 24576
    s_add_u32 s58, s28, s45
    s_and_b32 s58, s58, 3
    s_add_u32 s39, s58, 1
    s_and_b32 s39, s39, 3
    s_mul_i32 s39, s39, 786432
    v_add_u32 v37, s39, v41
    s_add_u32 s39, s58, 2
    s_and_b32 s39, s39, 3
    s_mul_i32 s39, s39, 786432
    v_add_u32 v38, s39, v41
    s_add_u32 s39, s58, 3
    s_and_b32 s39, s39, 3
    s_mul_i32 s39, s39, 786432
    v_add_u32 v39, s39, v41
    s_add_u32 s39, s58, 4
    s_and_b32 s39, s39, 3
    s_mul_i32 s39, s39, 786432
    v_add_u32 v40, s39, v41
    s_mul_i32 s39, s28, 2816
    s_add_u32 s39, s39, 61440
    v_and_b32 v4, 15, v1
    v_lshrrev_b32 v5, 4, v1
    v_mul_u32_u24 v4, 176, v4
    v_lshl_add_u32 v4, v5, 3, v4
    v_add_u32 v46, s39, v4
    v_add_u32 v4, 0, v1
    v_mul_u32_u24 v5, 205, v4
    v_lshrrev_b32 v5, 11, v5
    v_lshlrev_b32 v4, 4, v4
    v_lshl_add_u32 v52, v5, 4, v4
    v_add_u32 v52, s39, v52
    v_mul_u32_u24 v5, 1120, v5
    v_add_u32 v55, v5, v4
    v_add_u32 v4, 64, v1
    v_mul_u32_u24 v5, 205, v4
    v_lshrrev_b32 v5, 11, v5
    v_lshlrev_b32 v4, 4, v4
    v_lshl_add_u32 v53, v5, 4, v4
    v_add_u32 v53, s39, v53
    v_mul_u32_u24 v5, 1120, v5
    v_add_u32 v56, v5, v4
    v_add_u32 v4, 128, v1
    v_min_u32 v4, 159, v4
    v_mul_u32_u24 v5, 205, v4
    v_lshrrev_b32 v5, 11, v5
    v_lshlrev_b32 v4, 4, v4
    v_lshl_add_u32 v54, v5, 4, v4
    v_add_u32 v54, s39, v54
    v_mul_u32_u24 v5, 1120, v5
    v_add_u32 v57, v5, v4
    s_lshl_b32 s39, s35, 2
    s_add_u32 s39, s39, s58
    s_mul_i32 s65, s39, 20480
    s_mul_i32 s40, s45, 160
    s_add_u32 s65, s65, s40
    s_mul_i32 s39, s28, 15360
    v_add_u32 v47, s39, v41
    s_add_u32 s39, s28, 1
    s_and_b32 s39, s39, 3
    s_mul_i32 s39, s39, 15360
    v_add_u32 v34, s39, v41
    s_add_u32 s39, s28, 2
    s_and_b32 s39, s39, 3
    s_mul_i32 s39, s39, 15360
    v_add_u32 v35, s39, v41
    s_add_u32 s39, s28, 3
    s_and_b32 s39, s39, 3
    s_mul_i32 s39, s39, 15360
    v_add_u32 v36, s39, v41
    s_mov_b32 s49, 0
    s_mov_b32 s97, 0
    s_lshl_b32 s98, s2, 2
    s_add_u32 s98, s98, s28
    buffer_load_dwordx4 v9, s[8:11], s72 offen offset:3072 lds
    s_add_u32 m0, s44, 49152
    s_nop 0
    buffer_load_dwordx4 v10, s[12:15], s73 offen offset:0 lds
    buffer_load_dwordx4 v11, s[12:15], s73 offen offset:1024 lds
    buffer_load_dwordx4 v12, s[12:15], s73 offen offset:2048 lds
    buffer_load_dwordx4 v13, s[12:15], s73 offen offset:3072 lds
    s_waitcnt lgkmcnt(0)
    s_mul_i32 s70, s96, 0x9E3779B1
    s_add_u32 s70, s70, 0x7F4A7C15
    s_mov_b32 s71, s70
    s_and_b32 s95, s96, 1
    s_lshl_b32 s59, s95, 15
    s_and_b32 s95, s96, 2
    s_lshl_b32 s95, s95, 30
    s_or_b32 s59, s59, s95
    s_and_b32 s95, s96, 4
    s_lshl_b32 s62, s95, 13
    s_and_b32 s95, s96, 8
    s_lshl_b32 s95, s95, 28
    s_or_b32 s62, s62, s95
    s_xor_b32 s99, s59, 0x80008000
    s_xor_b32 s100, s62, 0x80008000
    s_mov_b32 s101, 0
    s_add_u32 s96, s96, 1
    v_mov_b32 v28, s70
    s_waitcnt vmcnt(8)
    s_barrier
    ds_read_b128 v[128:131], v14 offset:0
    ds_read_b64_tr_b16 v[144:145], v16 offset:0
    ds_read_b64_tr_b16 v[146:147], v16 offset:1024
    ds_read_b128 v[132:135], v14 offset:2048
    ds_read_b128 v[136:139], v14 offset:4096
    ds_read_b128 v[140:143], v14 offset:6144
    ds_read_b64_tr_b16 v[148:149], v17 offset:0
    ds_read_b64_tr_b16 v[150:151], v17 offset:1024
    ds_read_b64_tr_b16 v[152:153], v18 offset:0
    ds_read_b64_tr_b16 v[154:155], v18 offset:1024
    ds_read_b64_tr_b16 v[156:157], v19 offset:0
    ds_read_b64_tr_b16 v[158:159], v19 offset:1024
    s_waitcnt lgkmcnt(9)
    v_mfma_f32_16x16x32_bf16 v[64:67], v[144:147], v[128:131], 0
    ds_read_b128 v[160:163], v15 offset:0
    s_waitcnt lgkmcnt(9)
    v_mfma_f32_16x16x32_bf16 v[68:71], v[144:147], v[132:135], 0
    s_add_u32 m0, s44, 65536
    s_nop 0
    buffer_load_dwordx4 v6, s[8:11], s76 offen offset:0 lds
    ds_read_b64_tr_b16 v[176:177], v16 offset:8192
    s_waitcnt lgkmcnt(9)
    v_mfma_f32_16x16x32_bf16 v[72:75], v[144:147], v[136:139], 0
    ds_read_b64_tr_b16 v[178:179], v16 offset:9216
    s_waitcnt lgkmcnt(9)
    v_mfma_f32_16x16x32_bf16 v[76:79], v[144:147], v[140:143], 0
    buffer_load_dwordx4 v7, s[8:11], s76 offen offset:1024 lds
    ds_read_b128 v[164:167], v15 offset:2048
    s_waitcnt lgkmcnt(8)
    v_mfma_f32_16x16x32_bf16 v[80:83], v[148:151], v[128:131], 0
    ds_read_b128 v[168:171], v15 offset:4096
    v_mfma_f32_16x16x32_bf16 v[84:87], v[148:151], v[132:135], 0
    buffer_load_dwordx4 v8, s[8:11], s76 offen offset:2048 lds
    ds_read_b128 v[172:175], v15 offset:6144
    v_mfma_f32_16x16x32_bf16 v[88:91], v[148:151], v[136:139], 0
    ds_read_b64_tr_b16 v[180:181], v17 offset:8192
    v_mfma_f32_16x16x32_bf16 v[92:95], v[148:151], v[140:143], 0
    buffer_load_dwordx4 v9, s[8:11], s76 offen offset:3072 lds
    ds_read_b64_tr_b16 v[182:183], v17 offset:9216
    s_waitcnt lgkmcnt(10)
    v_mfma_f32_16x16x32_bf16 v[96:99], v[152:155], v[128:131], 0
    ds_read_b64_tr_b16 v[184:185], v18 offset:8192
    v_mfma_f32_16x16x32_bf16 v[100:103], v[152:155], v[132:135], 0
    s_add_u32 m0, s44, 81920
    s_nop 0
    buffer_load_dwordx4 v10, s[12:15], s77 offen offset:0 lds
    ds_read_b64_tr_b16 v[186:187], v18 offset:9216
    v_mfma_f32_16x16x32_bf16 v[104:107], v[152:155], v[136:139], 0
    ds_read_b64_tr_b16 v[188:189], v19 offset:8192
    v_mfma_f32_16x16x32_bf16 v[108:111], v[152:155], v[140:143], 0
    buffer_load_dwordx4 v11, s[12:15], s77 offen offset:1024 lds
    ds_read_b64_tr_b16 v[190:191], v19 offset:9216
    s_waitcnt lgkmcnt(12)
    v_mfma_f32_16x16x32_bf16 v[112:115], v[156:159], v[128:131], 0
    v_mfma_f32_16x16x32_bf16 v[116:119], v[156:159], v[132:135], 0
    buffer_load_dwordx4 v12, s[12:15], s77 offen offset:2048 lds
    v_mfma_f32_16x16x32_bf16 v[120:123], v[156:159], v[136:139], 0
    v_mfma_f32_16x16x32_bf16 v[124:127], v[156:159], v[140:143], 0
    buffer_load_dwordx4 v13, s[12:15], s77 offen offset:3072 lds
    s_waitcnt vmcnt(8)
    s_barrier
    s_waitcnt lgkmcnt(6)
    v_mfma_f32_16x16x32_bf16 v[64:67], v[176:179], v[160:163], v[64:67]
    ds_read_b128 v[128:131], v14 offset:32768
    v_mfma_f32_16x16x32_bf16 v[68:71], v[176:179], v[164:167], v[68:71]
    s_add_u32 m0, s44, 98304
    s_nop 0
    buffer_load_dwordx4 v6, s[8:11], s78 offen offset:0 lds
    v_mfma_f32_16x16x32_bf16 v[72:75], v[176:179], v[168:171], v[72:75]
    ds_read_b64_tr_b16 v[144:145], v16 offset:32768
    v_mfma_f32_16x16x32_bf16 v[76:79], v[176:179], v[172:175], v[76:79]
    ds_read_b64_tr_b16 v[146:147], v16 offset:33792
    s_waitcnt lgkmcnt(7)
    v_mfma_f32_16x16x32_bf16 v[80:83], v[180:183], v[160:163], v[80:83]
    ds_read_b128 v[132:135], v14 offset:34816
    v_mfma_f32_16x16x32_bf16 v[84:87], v[180:183], v[164:167], v[84:87]
    buffer_load_dwordx4 v7, s[8:11], s78 offen offset:1024 lds
    v_mfma_f32_16x16x32_bf16 v[88:91], v[180:183], v[168:171], v[88:91]
    ds_read_b128 v[136:139], v14 offset:36864
    v_mfma_f32_16x16x32_bf16 v[92:95], v[180:183], v[172:175], v[92:95]
    ds_read_b128 v[140:143], v14 offset:38912
    s_waitcnt lgkmcnt(8)
    v_mfma_f32_16x16x32_bf16 v[96:99], v[184:187], v[160:163], v[96:99]
    ds_read_b64_tr_b16 v[148:149], v17 offset:32768
    v_mfma_f32_16x16x32_bf16 v[100:103], v[184:187], v[164:167], v[100:103]
    buffer_load_dwordx4 v8, s[8:11], s78 offen offset:2048 lds
    v_mfma_f32_16x16x32_bf16 v[104:107], v[184:187], v[168:171], v[104:107]
    ds_read_b64_tr_b16 v[150:151], v17 offset:33792
    v_mfma_f32_16x16x32_bf16 v[108:111], v[184:187], v[172:175], v[108:111]
    ds_read_b64_tr_b16 v[152:153], v18 offset:32768
    s_waitcnt lgkmcnt(9)
    v_mfma_f32_16x16x32_bf16 v[112:115], v[188:191], v[160:163], v[112:115]
    ds_read_b64_tr_b16 v[154:155], v18 offset:33792
    v_mfma_f32_16x16x32_bf16 v[116:119], v[188:191], v[164:167], v[116:119]
    buffer_load_dwordx4 v9, s[8:11], s78 offen offset:3072 lds
    v_mfma_f32_16x16x32_bf16 v[120:123], v[188:191], v[168:171], v[120:123]
    ds_read_b64_tr_b16 v[156:157], v19 offset:32768
    v_mfma_f32_16x16x32_bf16 v[124:127], v[188:191], v[172:175], v[124:127]
    ds_read_b64_tr_b16 v[158:159], v19 offset:33792
    s_add_u32 m0, s44, 114688
    s_waitcnt lgkmcnt(6)
    v_mfma_f32_16x16x32_bf16 v[64:67], v[144:147], v[128:131], v[64:67]
    ds_read_b128 v[160:163], v15 offset:32768
    v_mfma_f32_16x16x32_bf16 v[68:71], v[144:147], v[132:135], v[68:71]
    buffer_load_dwordx4 v10, s[12:15], s79 offen offset:0 lds
    v_mfma_f32_16x16x32_bf16 v[72:75], v[144:147], v[136:139], v[72:75]
    ds_read_b64_tr_b16 v[176:177], v16 offset:40960
    v_mfma_f32_16x16x32_bf16 v[76:79], v[144:147], v[140:143], v[76:79]
    ds_read_b64_tr_b16 v[178:179], v16 offset:41984
    s_waitcnt lgkmcnt(7)
    v_mfma_f32_16x16x32_bf16 v[80:83], v[148:151], v[128:131], v[80:83]
    ds_read_b128 v[164:167], v15 offset:34816
    v_mfma_f32_16x16x32_bf16 v[84:87], v[148:151], v[132:135], v[84:87]
    buffer_load_dwordx4 v11, s[12:15], s79 offen offset:1024 lds
    v_mfma_f32_16x16x32_bf16 v[88:91], v[148:151], v[136:139], v[88:91]
    ds_read_b128 v[168:171], v15 offset:36864
    v_mfma_f32_16x16x32_bf16 v[92:95], v[148:151], v[140:143], v[92:95]
    ds_read_b128 v[172:175], v15 offset:38912
    s_waitcnt lgkmcnt(8)
    v_mfma_f32_16x16x32_bf16 v[96:99], v[152:155], v[128:131], v[96:99]
    ds_read_b64_tr_b16 v[180:181], v17 offset:40960
    v_mfma_f32_16x16x32_bf16 v[100:103], v[152:155], v[132:135], v[100:103]
    buffer_load_dwordx4 v12, s[12:15], s79 offen offset:2048 lds
    v_mfma_f32_16x16x32_bf16 v[104:107], v[152:155], v[136:139], v[104:107]
    ds_read_b64_tr_b16 v[182:183], v17 offset:41984
    v_mfma_f32_16x16x32_bf16 v[108:111], v[152:155], v[140:143], v[108:111]
    ds_read_b64_tr_b16 v[184:185], v18 offset:40960
    s_waitcnt lgkmcnt(9)
    v_mfma_f32_16x16x32_bf16 v[112:115], v[156:159], v[128:131], v[112:115]
    ds_read_b64_tr_b16 v[186:187], v18 offset:41984
    v_mfma_f32_16x16x32_bf16 v[116:119], v[156:159], v[132:135], v[116:119]
    buffer_load_dwordx4 v13, s[12:15], s79 offen offset:3072 lds
    v_mfma_f32_16x16x32_bf16 v[120:123], v[156:159], v[136:139], v[120:123]
    ds_read_b64_tr_b16 v[188:189], v19 offset:40960
    v_mfma_f32_16x16x32_bf16 v[124:127], v[156:159], v[140:143], v[124:127]
    ds_read_b64_tr_b16 v[190:191], v19 offset:41984
    s_add_u32 m0, s44, 0
    s_waitcnt vmcnt(8)
    s_barrier
    s_waitcnt lgkmcnt(6)
    v_mfma_f32_16x16x32_bf16 v[64:67], v[176:179], v[160:163], v[64:67]
    ds_read_b128 v[128:131], v20 offset:0
    v_mfma_f32_16x16x32_bf16 v[68:71], v[176:179], v[164:167], v[68:71]
    buffer_load_dwordx4 v6, s[8:11], s80 offen offset:0 lds
    v_mfma_f32_16x16x32_bf16 v[72:75], v[176:179], v[168:171], v[72:75]
    ds_read_b64_tr_b16 v[144:145], v22 offset:0
    v_mfma_f32_16x16x32_bf16 v[76:79], v[176:179], v[172:175], v[76:79]
    ds_read_b64_tr_b16 v[146:147], v22 offset:1024
    s_waitcnt lgkmcnt(7)
    v_mfma_f32_16x16x32_bf16 v[80:83], v[180:183], v[160:163], v[80:83]
    ds_read_b128 v[132:135], v20 offset:2048
    v_mfma_f32_16x16x32_bf16 v[84:87], v[180:183], v[164:167], v[84:87]
    buffer_load_dwordx4 v7, s[8:11], s80 offen offset:1024 lds
    v_mfma_f32_16x16x32_bf16 v[88:91], v[180:183], v[168:171], v[88:91]
    ds_read_b128 v[136:139], v20 offset:4096
    v_mfma_f32_16x16x32_bf16 v[92:95], v[180:183], v[172:175], v[92:95]
    ds_read_b128 v[140:143], v20 offset:6144
    s_waitcnt lgkmcnt(8)
    v_mfma_f32_16x16x32_bf16 v[96:99], v[184:187], v[160:163], v[96:99]
    ds_read_b64_tr_b16 v[148:149], v23 offset:0
    v_mfma_f32_16x16x32_bf16 v[100:103], v[184:187], v[164:167], v[100:103]
    buffer_load_dwordx4 v8, s[8:11], s80 offen offset:2048 lds
    v_mfma_f32_16x16x32_bf16 v[104:107], v[184:187], v[168:171], v[104:107]
    ds_read_b64_tr_b16 v[150:151], v23 offset:1024
    v_mfma_f32_16x16x32_bf16 v[108:111], v[184:187], v[172:175], v[108:111]
    ds_read_b64_tr_b16 v[152:153], v24 offset:0
    s_waitcnt lgkmcnt(9)
    v_mfma_f32_16x16x32_bf16 v[112:115], v[188:191], v[160:163], v[112:115]
    ds_read_b64_tr_b16 v[154:155], v24 offset:1024
    v_mfma_f32_16x16x32_bf16 v[116:119], v[188:191], v[164:167], v[116:119]
    buffer_load_dwordx4 v9, s[8:11], s80 offen offset:3072 lds
    v_mfma_f32_16x16x32_bf16 v[120:123], v[188:191], v[168:171], v[120:123]
    ds_read_b64_tr_b16 v[156:157], v25 offset:0
    v_mfma_f32_16x16x32_bf16 v[124:127], v[188:191], v[172:175], v[124:127]
    ds_read_b64_tr_b16 v[158:159], v25 offset:1024
    s_add_u32 m0, s44, 16384
    s_waitcnt lgkmcnt(6)
    v_mfma_f32_16x16x32_bf16 v[64:67], v[144:147], v[128:131], v[64:67]
    ds_read_b128 v[160:163], v21 offset:0
    v_mfma_f32_16x16x32_bf16 v[68:71], v[144:147], v[132:135], v[68:71]
    buffer_load_dwordx4 v10, s[12:15], s81 offen offset:0 lds
    v_mfma_f32_16x16x32_bf16 v[72:75], v[144:147], v[136:139], v[72:75]
    ds_read_b64_tr_b16 v[176:177], v22 offset:8192
    v_mfma_f32_16x16x32_bf16 v[76:79], v[144:147], v[140:143], v[76:79]
    ds_read_b64_tr_b16 v[178:179], v22 offset:9216
    s_waitcnt lgkmcnt(7)
    v_mfma_f32_16x16x32_bf16 v[80:83], v[148:151], v[128:131], v[80:83]
    ds_read_b128 v[164:167], v21 offset:2048
    v_mfma_f32_16x16x32_bf16 v[84:87], v[148:151], v[132:135], v[84:87]
    buffer_load_dwordx4 v11, s[12:15], s81 offen offset:1024 lds
    v_mfma_f32_16x16x32_bf16 v[88:91], v[148:151], v[136:139], v[88:91]
    ds_read_b128 v[168:171], v21 offset:4096
    v_mfma_f32_16x16x32_bf16 v[92:95], v[148:151], v[140:143], v[92:95]
    ds_read_b128 v[172:175], v21 offset:6144
    s_waitcnt lgkmcnt(8)
    v_mfma_f32_16x16x32_bf16 v[96:99], v[152:155], v[128:131], v[96:99]
    ds_read_b64_tr_b16 v[180:181], v23 offset:8192
    v_mfma_f32_16x16x32_bf16 v[100:103], v[152:155], v[132:135], v[100:103]
    buffer_load_dwordx4 v12, s[12:15], s81 offen offset:2048 lds
    v_mfma_f32_16x16x32_bf16 v[104:107], v[152:155], v[136:139], v[104:107]
    ds_read_b64_tr_b16 v[182:183], v23 offset:9216
    v_mfma_f32_16x16x32_bf16 v[108:111], v[152:155], v[140:143], v[108:111]
    ds_read_b64_tr_b16 v[184:185], v24 offset:8192
    s_waitcnt lgkmcnt(9)
    v_mfma_f32_16x16x32_bf16 v[112:115], v[156:159], v[128:131], v[112:115]
    ds_read_b64_tr_b16 v[186:187], v24 offset:9216
    v_mfma_f32_16x16x32_bf16 v[116:119], v[156:159], v[132:135], v[116:119]
    buffer_load_dwordx4 v13, s[12:15], s81 offen offset:3072 lds
    v_mfma_f32_16x16x32_bf16 v[120:123], v[156:159], v[136:139], v[120:123]
    ds_read_b64_tr_b16 v[188:189], v25 offset:8192
    v_mfma_f32_16x16x32_bf16 v[124:127], v[156:159], v[140:143], v[124:127]
    ds_read_b64_tr_b16 v[190:191], v25 offset:9216
    s_add_u32 m0, s44, 32768
    s_waitcnt vmcnt(8)
    s_barrier
    s_waitcnt lgkmcnt(6)
    v_mfma_f32_16x16x32_bf16 v[64:67], v[176:179], v[160:163], v[64:67]
    ds_read_b128 v[128:131], v20 offset:32768
    v_mfma_f32_16x16x32_bf16 v[68:71], v[176:179], v[164:167], v[68:71]
    buffer_load_dwordx4 v6, s[8:11], s82 offen offset:0 lds
    v_mfma_f32_16x16x32_bf16 v[72:75], v[176:179], v[168:171], v[72:75]
    ds_read_b64_tr_b16 v[144:145], v22 offset:32768
    v_mfma_f32_16x16x32_bf16 v[76:79], v[176:179], v[172:175], v[76:79]
    ds_read_b64_tr_b16 v[146:147], v22 offset:33792
    s_waitcnt lgkmcnt(7)
    v_mfma_f32_16x16x32_bf16 v[80:83], v[180:183], v[160:163], v[80:83]
    ds_read_b128 v[132:135], v20 offset:34816
    v_mfma_f32_16x16x32_bf16 v[84:87], v[180:183], v[164:167], v[84:87]
    buffer_load_dwordx4 v7, s[8:11], s82 offen offset:1024 lds
    v_mfma_f32_16x16x32_bf16 v[88:91], v[180:183], v[168:171], v[88:91]
    ds_read_b128 v[136:139], v20 offset:36864
    v_mfma_f32_16x16x32_bf16 v[92:95], v[180:183], v[172:175], v[92:95]
    ds_read_b128 v[140:143], v20 offset:38912
    s_waitcnt lgkmcnt(8)
    v_mfma_f32_16x16x32_bf16 v[96:99], v[184:187], v[160:163], v[96:99]
    ds_read_b64_tr_b16 v[148:149], v23 offset:32768
    v_mfma_f32_16x16x32_bf16 v[100:103], v[184:187], v[164:167], v[100:103]
    buffer_load_dwordx4 v8, s[8:11], s82 offen offset:2048 lds
    v_mfma_f32_16x16x32_bf16 v[104:107], v[184:187], v[168:171], v[104:107]
    ds_read_b64_tr_b16 v[150:151], v23 offset:33792
    v_mfma_f32_16x16x32_bf16 v[108:111], v[184:187], v[172:175], v[108:111]
    ds_read_b64_tr_b16 v[152:153], v24 offset:32768
    s_waitcnt lgkmcnt(9)
    v_mfma_f32_16x16x32_bf16 v[112:115], v[188:191], v[160:163], v[112:115]
    ds_read_b64_tr_b16 v[154:155], v24 offset:33792
    v_mfma_f32_16x16x32_bf16 v[116:119], v[188:191], v[164:167], v[116:119]
    buffer_load_dwordx4 v9, s[8:11], s82 offen offset:3072 lds
    v_mfma_f32_16x16x32_bf16 v[120:123], v[188:191], v[168:171], v[120:123]
    ds_read_b64_tr_b16 v[156:157], v25 offset:32768
    v_mfma_f32_16x16x32_bf16 v[124:127], v[188:191], v[172:175], v[124:127]
    ds_read_b64_tr_b16 v[158:159], v25 offset:33792
    s_add_u32 m0, s44, 49152
    s_waitcnt lgkmcnt(6)
    v_mfma_f32_16x16x32_bf16 v[64:67], v[144:147], v[128:131], v[64:67]
    ds_read_b128 v[160:163], v21 offset:32768
    v_mfma_f32_16x16x32_bf16 v[68:71], v[144:147], v[132:135], v[68:71]
    buffer_load_dwordx4 v10, s[12:15], s83 offen offset:0 lds
    v_mfma_f32_16x16x32_bf16 v[72:75], v[144:147], v[136:139], v[72:75]
    ds_read_b64_tr_b16 v[176:177], v22 offset:40960
    v_mfma_f32_16x16x32_bf16 v[76:79], v[144:147], v[140:143], v[76:79]
    ds_read_b64_tr_b16 v[178:179], v22 offset:41984
    s_waitcnt lgkmcnt(7)
    v_mfma_f32_16x16x32_bf16 v[80:83], v[148:151], v[128:131], v[80:83]
    ds_read_b128 v[164:167], v21 offset:34816
    v_mfma_f32_16x16x32_bf16 v[84:87], v[148:151], v[132:135], v[84:87]
    buffer_load_dwordx4 v11, s[12:15], s83 offen offset:1024 lds
    v_mfma_f32_16x16x32_bf16 v[88:91], v[148:151], v[136:139], v[88:91]
    ds_read_b128 v[168:171], v21 offset:36864
    v_mfma_f32_16x16x32_bf16 v[92:95], v[148:151], v[140:143], v[92:95]
    ds_read_b128 v[172:175], v21 offset:38912
    s_waitcnt lgkmcnt(8)
    v_mfma_f32_16x16x32_bf16 v[96:99], v[152:155], v[128:131], v[96:99]
    ds_read_b64_tr_b16 v[180:181], v23 offset:40960
    v_mfma_f32_16x16x32_bf16 v[100:103], v[152:155], v[132:135], v[100:103]
    buffer_load_dwordx4 v12, s[12:15], s83 offen offset:2048 lds
    v_mfma_f32_16x16x32_bf16 v[104:107], v[152:155], v[136:139], v[104:107]
    ds_read_b64_tr_b16 v[182:183], v23 offset:41984
    v_mfma_f32_16x16x32_bf16 v[108:111], v[152:155], v[140:143], v[108:111]
    ds_read_b64_tr_b16 v[184:185], v24 offset:40960
    s_waitcnt lgkmcnt(9)
    v_mfma_f32_16x16x32_bf16 v[112:115], v[156:159], v[128:131], v[112:115]
    ds_read_b64_tr_b16 v[186:187], v24 offset:41984
    v_mfma_f32_16x16x32_bf16 v[116:119], v[156:159], v[132:135], v[116:119]
    buffer_load_dwordx4 v13, s[12:15], s83 offen offset:3072 lds
    v_mfma_f32_16x16x32_bf16 v[120:123], v[156:159], v[136:139], v[120:123]
    ds_read_b64_tr_b16 v[188:189], v25 offset:40960
    v_mfma_f32_16x16x32_bf16 v[124:127], v[156:159], v[140:143], v[124:127]
    ds_read_b64_tr_b16 v[190:191], v25 offset:41984
    s_add_u32 m0, s44, 65536
    s_waitcnt vmcnt(8)
    s_barrier
    s_waitcnt lgkmcnt(6)
    v_mfma_f32_16x16x32_bf16 v[64:67], v[176:179], v[160:163], v[64:67]
    ds_read_b128 v[128:131], v14 offset:0
    v_mfma_f32_16x16x32_bf16 v[68:71], v[176:179], v[164:167], v[68:71]
    buffer_load_dwordx4 v6, s[8:11], s84 offen offset:0 lds
    v_mfma_f32_16x16x32_bf16 v[72:75], v[176:179], v[168:171], v[72:75]
    ds_read_b64_tr_b16 v[144:145], v16 offset:0
    v_mfma_f32_16x16x32_bf16 v[76:79], v[176:179], v[172:175], v[76:79]
    ds_read_b64_tr_b16 v[146:147], v16 offset:1024
    s_waitcnt lgkmcnt(7)
    v_mfma_f32_16x16x32_bf16 v[80:83], v[180:183], v[160:163], v[80:83]
    ds_read_b128 v[132:135], v14 offset:2048
    v_mfma_f32_16x16x32_bf16 v[84:87], v[180:183], v[164:167], v[84:87]
    buffer_load_dwordx4 v7, s[8:11], s84 offen offset:1024 lds
    v_mfma_f32_16x16x32_bf16 v[88:91], v[180:183], v[168:171], v[88:91]
    ds_read_b128 v[136:139], v14 offset:4096
    v_mfma_f32_16x16x32_bf16 v[92:95], v[180:183], v[172:175], v[92:95]
    ds_read_b128 v[140:143], v14 offset:6144
    s_waitcnt lgkmcnt(8)
    v_mfma_f32_16x16x32_bf16 v[96:99], v[184:187], v[160:163], v[96:99]
    ds_read_b64_tr_b16 v[148:149], v17 offset:0
    v_mfma_f32_16x16x32_bf16 v[100:103], v[184:187], v[164:167], v[100:103]
    buffer_load_dwordx4 v8, s[8:11], s84 offen offset:2048 lds
    v_mfma_f32_16x16x32_bf16 v[104:107], v[184:187], v[168:171], v[104:107]
    ds_read_b64_tr_b16 v[150:151], v17 offset:1024
    v_mfma_f32_16x16x32_bf16 v[108:111], v[184:187], v[172:175], v[108:111]
    ds_read_b64_tr_b16 v[152:153], v18 offset:0
    s_waitcnt lgkmcnt(9)
    v_mfma_f32_16x16x32_bf16 v[112:115], v[188:191], v[160:163], v[112:115]
    ds_read_b64_tr_b16 v[154:155], v18 offset:1024
    v_mfma_f32_16x16x32_bf16 v[116:119], v[188:191], v[164:167], v[116:119]
    buffer_load_dwordx4 v9, s[8:11], s84 offen offset:3072 lds
    v_mfma_f32_16x16x32_bf16 v[120:123], v[188:191], v[168:171], v[120:123]
    ds_read_b64_tr_b16 v[156:157], v19 offset:0
    v_mfma_f32_16x16x32_bf16 v[124:127], v[188:191], v[172:175], v[124:127]
    ds_read_b64_tr_b16 v[158:159], v19 offset:1024
    s_add_u32 m0, s44, 81920
    s_waitcnt lgkmcnt(6)
    v_mfma_f32_16x16x32_bf16 v[64:67], v[144:147], v[128:131], v[64:67]
    ds_read_b128 v[160:163], v15 offset:0
    v_mfma_f32_16x16x32_bf16 v[68:71], v[144:147], v[132:135], v[68:71]
    buffer_load_dwordx4 v10, s[12:15], s85 offen offset:0 lds
    v_mfma_f32_16x16x32_bf16 v[72:75], v[144:147], v[136:139], v[72:75]
    ds_read_b64_tr_b16 v[176:177], v16 offset:8192
    v_mfma_f32_16x16x32_bf16 v[76:79], v[144:147], v[140:143], v[76:79]
    ds_read_b64_tr_b16 v[178:179], v16 offset:9216
    s_waitcnt lgkmcnt(7)
    v_mfma_f32_16x16x32_bf16 v[80:83], v[148:151], v[128:131], v[80:83]
    ds_read_b128 v[164:167], v15 offset:2048
    v_mfma_f32_16x16x32_bf16 v[84:87], v[148:151], v[132:135], v[84:87]
    buffer_load_dwordx4 v11, s[12:15], s85 offen offset:1024 lds
    v_mfma_f32_16x16x32_bf16 v[88:91], v[148:151], v[136:139], v[88:91]
    ds_read_b128 v[168:171], v15 offset:4096
    v_mfma_f32_16x16x32_bf16 v[92:95], v[148:151], v[140:143], v[92:95]
    ds_read_b128 v[172:175], v15 offset:6144
    s_waitcnt lgkmcnt(8)
    v_mfma_f32_16x16x32_bf16 v[96:99], v[152:155], v[128:131], v[96:99]
    ds_read_b64_tr_b16 v[180:181], v17 offset:8192
    v_mfma_f32_16x16x32_bf16 v[100:103], v[152:155], v[132:135], v[100:103]
    buffer_load_dwordx4 v12, s[12:15], s85 offen offset:2048 lds
    v_mfma_f32_16x16x32_bf16 v[104:107], v[152:155], v[136:139], v[104:107]
    ds_read_b64_tr_b16 v[182:183], v17 offset:9216
    v_mfma_f32_16x16x32_bf16 v[108:111], v[152:155], v[140:143], v[108:111]
    ds_read_b64_tr_b16 v[184:185], v18 offset:8192
    s_waitcnt lgkmcnt(9)
    v_mfma_f32_16x16x32_bf16 v[112:115], v[156:159], v[128:131], v[112:115]
    ds_read_b64_tr_b16 v[186:187], v18 offset:9216
    v_mfma_f32_16x16x32_bf16 v[116:119], v[156:159], v[132:135], v[116:119]
    buffer_load_dwordx4 v13, s[12:15], s85 offen offset:3072 lds
    v_mfma_f32_16x16x32_bf16 v[120:123], v[156:159], v[136:139], v[120:123]
    ds_read_b64_tr_b16 v[188:189], v19 offset:8192
    v_mfma_f32_16x16x32_bf16 v[124:127], v[156:159], v[140:143], v[124:127]
    ds_read_b64_tr_b16 v[190:191], v19 offset:9216
    s_add_u32 m0, s44, 98304
    s_waitcnt vmcnt(8)
    s_barrier
    s_waitcnt lgkmcnt(6)
    v_mfma_f32_16x16x32_bf16 v[64:67], v[176:179], v[160:163], v[64:67]
    ds_read_b128 v[128:131], v14 offset:32768
    v_mfma_f32_16x16x32_bf16 v[68:71], v[176:179], v[164:167], v[68:71]
    buffer_load_dwordx4 v6, s[8:11], s86 offen offset:0 lds
    v_mfma_f32_16x16x32_bf16 v[72:75], v[176:179], v[168:171], v[72:75]
    ds_read_b64_tr_b16 v[144:145], v16 offset:32768
    v_mfma_f32_16x16x32_bf16 v[76:79], v[176:179], v[172:175], v[76:79]
    ds_read_b64_tr_b16 v[146:147], v16 offset:33792
    s_waitcnt lgkmcnt(7)
    v_mfma_f32_16x16x32_bf16 v[80:83], v[180:183], v[160:163], v[80:83]
    ds_read_b128 v[132:135], v14 offset:34816
    v_mfma_f32_16x16x32_bf16 v[84:87], v[180:183], v[164:167], v[84:87]
    buffer_load_dwordx4 v7, s[8:11], s86 offen offset:1024 lds
    v_mfma_f32_16x16x32_bf16 v[88:91], v[180:183], v[168:171], v[88:91]
    ds_read_b128 v[136:139], v14 offset:36864
    v_mfma_f32_16x16x32_bf16 v[92:95], v[180:183], v[172:175], v[92:95]
    ds_read_b128 v[140:143], v14 offset:38912
    s_waitcnt lgkmcnt(8)
    v_mfma_f32_16x16x32_bf16 v[96:99], v[184:187], v[160:163], v[96:99]
    ds_read_b64_tr_b16 v[148:149], v17 offset:32768
    v_mfma_f32_16x16x32_bf16 v[100:103], v[184:187], v[164:167], v[100:103]
    buffer_load_dwordx4 v8, s[8:11], s86 offen offset:2048 lds
    v_mfma_f32_16x16x32_bf16 v[104:107], v[184:187], v[168:171], v[104:107]
    ds_read_b64_tr_b16 v[150:151], v17 offset:33792
    v_mfma_f32_16x16x32_bf16 v[108:111], v[184:187], v[172:175], v[108:111]
    ds_read_b64_tr_b16 v[152:153], v18 offset:32768
    s_waitcnt lgkmcnt(9)
    v_mfma_f32_16x16x32_bf16 v[112:115], v[188:191], v[160:163], v[112:115]
    ds_read_b64_tr_b16 v[154:155], v18 offset:33792
    v_mfma_f32_16x16x32_bf16 v[116:119], v[188:191], v[164:167], v[116:119]
    buffer_load_dwordx4 v9, s[8:11], s86 offen offset:3072 lds
    v_mfma_f32_16x16x32_bf16 v[120:123], v[188:191], v[168:171], v[120:123]
    ds_read_b64_tr_b16 v[156:157], v19 offset:32768
    v_mfma_f32_16x16x32_bf16 v[124:127], v[188:191], v[172:175], v[124:127]
    ds_read_b64_tr_b16 v[158:159], v19 offset:33792
    s_add_u32 m0, s44, 114688
    s_waitcnt lgkmcnt(6)
    v_mfma_f32_16x16x32_bf16 v[64:67], v[144:147], v[128:131], v[64:67]
    ds_read_b128 v[160:163], v15 offset:32768
    v_mfma_f32_16x16x32_bf16 v[68:71], v[144:147], v[132:135], v[68:71]
    buffer_load_dwordx4 v10, s[12:15], s87 offen offset:0 lds
    v_mfma_f32_16x16x32_bf16 v[72:75], v[144:147], v[136:139], v[72:75]
    ds_read_b64_tr_b16 v[176:177], v16 offset:40960
    v_mfma_f32_16x16x32_bf16 v[76:79], v[144:147], v[140:143], v[76:79]
    ds_read_b64_tr_b16 v[178:179], v16 offset:41984
    s_waitcnt lgkmcnt(7)
    v_mfma_f32_16x16x32_bf16 v[80:83], v[148:151], v[128:131], v[80:83]
    ds_read_b128 v[164:167], v15 offset:34816
    v_mfma_f32_16x16x32_bf16 v[84:87], v[148:151], v[132:135], v[84:87]
    buffer_load_dwordx4 v11, s[12:15], s87 offen offset:1024 lds
    v_mfma_f32_16x16x32_bf16 v[88:91], v[148:151], v[136:139], v[88:91]
    ds_read_b128 v[168:171], v15 offset:36864
    v_mfma_f32_16x16x32_bf16 v[92:95], v[148:151], v[140:143], v[92:95]
    ds_read_b128 v[172:175], v15 offset:38912
    s_waitcnt lgkmcnt(8)
    v_mfma_f32_16x16x32_bf16 v[96:99], v[152:155], v[128:131], v[96:99]
    ds_read_b64_tr_b16 v[180:181], v17 offset:40960
    v_mfma_f32_16x16x32_bf16 v[100:103], v[152:155], v[132:135], v[100:103]
    buffer_load_dwordx4 v12, s[12:15], s87 offen offset:2048 lds
    v_mfma_f32_16x16x32_bf16 v[104:107], v[152:155], v[136:139], v[104:107]
    ds_read_b64_tr_b16 v[182:183], v17 offset:41984
    v_mfma_f32_16x16x32_bf16 v[108:111], v[152:155], v[140:143], v[108:111]
    ds_read_b64_tr_b16 v[184:185], v18 offset:40960
    s_waitcnt lgkmcnt(9)
    v_mfma_f32_16x16x32_bf16 v[112:115], v[156:159], v[128:131], v[112:115]
    ds_read_b64_tr_b16 v[186:187], v18 offset:41984
    v_mfma_f32_16x16x32_bf16 v[116:119], v[156:159], v[132:135], v[116:119]
    buffer_load_dwordx4 v13, s[12:15], s87 offen offset:3072 lds
    v_mfma_f32_16x16x32_bf16 v[120:123], v[156:159], v[136:139], v[120:123]
    ds_read_b64_tr_b16 v[188:189], v19 offset:40960
    buffer_load_dword v49, v48, s[24:27], s64 offen sc1
    v_mfma_f32_16x16x32_bf16 v[124:127], v[156:159], v[140:143], v[124:127]
    ds_read_b64_tr_b16 v[190:191], v19 offset:41984
    s_add_u32 m0, s44, 0
    s_waitcnt vmcnt(9)
    s_barrier
    s_waitcnt lgkmcnt(6)
    v_mfma_f32_16x16x32_bf16 v[64:67], v[176:179], v[160:163], v[64:67]
    ds_read_b128 v[128:131], v20 offset:0
    v_mfma_f32_16x16x32_bf16 v[68:71], v[176:179], v[164:167], v[68:71]
    buffer_load_dwordx4 v6, s[8:11], s88 offen offset:0 lds
    v_mfma_f32_16x16x32_bf16 v[72:75], v[176:179], v[168:171], v[72:75]
    ds_read_b64_tr_b16 v[144:145], v22 offset:0
    v_mfma_f32_16x16x32_bf16 v[76:79], v[176:179], v[172:175], v[76:79]
    ds_read_b64_tr_b16 v[146:147], v22 offset:1024
    s_waitcnt lgkmcnt(7)
    v_mfma_f32_16x16x32_bf16 v[80:83], v[180:183], v[160:163], v[80:83]
    ds_read_b128 v[132:135], v20 offset:2048
    v_mfma_f32_16x16x32_bf16 v[84:87], v[180:183], v[164:167], v[84:87]
    buffer_load_dwordx4 v7, s[8:11], s88 offen offset:1024 lds
    v_mfma_f32_16x16x32_bf16 v[88:91], v[180:183], v[168:171], v[88:91]
    ds_read_b128 v[136:139], v20 offset:4096
    v_mfma_f32_16x16x32_bf16 v[92:95], v[180:183], v[172:175], v[92:95]
    ds_read_b128 v[140:143], v20 offset:6144
    s_waitcnt lgkmcnt(8)
    v_mfma_f32_16x16x32_bf16 v[96:99], v[184:187], v[160:163], v[96:99]
    ds_read_b64_tr_b16 v[148:149], v23 offset:0
    v_mfma_f32_16x16x32_bf16 v[100:103], v[184:187], v[164:167], v[100:103]
    buffer_load_dwordx4 v8, s[8:11], s88 offen offset:2048 lds
    v_mfma_f32_16x16x32_bf16 v[104:107], v[184:187], v[168:171], v[104:107]
    ds_read_b64_tr_b16 v[150:151], v23 offset:1024
    v_mfma_f32_16x16x32_bf16 v[108:111], v[184:187], v[172:175], v[108:111]
    ds_read_b64_tr_b16 v[152:153], v24 offset:0
    s_waitcnt lgkmcnt(9)
    v_mfma_f32_16x16x32_bf16 v[112:115], v[188:191], v[160:163], v[112:115]
    ds_read_b64_tr_b16 v[154:155], v24 offset:1024
    v_mfma_f32_16x16x32_bf16 v[116:119], v[188:191], v[164:167], v[116:119]
    buffer_load_dwordx4 v9, s[8:11], s88 offen offset:3072 lds
    v_mfma_f32_16x16x32_bf16 v[120:123], v[188:191], v[168:171], v[120:123]
    ds_read_b64_tr_b16 v[156:157], v25 offset:0
    v_mfma_f32_16x16x32_bf16 v[124:127], v[188:191], v[172:175], v[124:127]
    ds_read_b64_tr_b16 v[158:159], v25 offset:1024
    s_add_u32 m0, s44, 16384
    s_waitcnt lgkmcnt(6)
    v_mfma_f32_16x16x32_bf16 v[64:67], v[144:147], v[128:131], v[64:67]
    ds_read_b128 v[160:163], v21 offset:0
    v_mfma_f32_16x16x32_bf16 v[68:71], v[144:147], v[132:135], v[68:71]
    buffer_load_dwordx4 v10, s[12:15], s89 offen offset:0 lds
    v_mfma_f32_16x16x32_bf16 v[72:75], v[144:147], v[136:139], v[72:75]
    ds_read_b64_tr_b16 v[176:177], v22 offset:8192
    v_mfma_f32_16x16x32_bf16 v[76:79], v[144:147], v[140:143], v[76:79]
    ds_read_b64_tr_b16 v[178:179], v22 offset:9216
    s_waitcnt lgkmcnt(7)
    v_mfma_f32_16x16x32_bf16 v[80:83], v[148:151], v[128:131], v[80:83]
    ds_read_b128 v[164:167], v21 offset:2048
    v_mfma_f32_16x16x32_bf16 v[84:87], v[148:151], v[132:135], v[84:87]
    buffer_load_dwordx4 v11, s[12:15], s89 offen offset:1024 lds
    v_mfma_f32_16x16x32_bf16 v[88:91], v[148:151], v[136:139], v[88:91]
    ds_read_b128 v[168:171], v21 offset:4096
    v_mfma_f32_16x16x32_bf16 v[92:95], v[148:151], v[140:143], v[92:95]
    ds_read_b128 v[172:175], v21 offset:6144
    s_waitcnt lgkmcnt(8)
    v_mfma_f32_16x16x32_bf16 v[96:99], v[152:155], v[128:131], v[96:99]
    ds_read_b64_tr_b16 v[180:181], v23 offset:8192
    v_mfma_f32_16x16x32_bf16 v[100:103], v[152:155], v[132:135], v[100:103]
    buffer_load_dwordx4 v12, s[12:15], s89 offen offset:2048 lds
    v_mfma_f32_16x16x32_bf16 v[104:107], v[152:155], v[136:139], v[104:107]
    ds_read_b64_tr_b16 v[182:183], v23 offset:9216
    v_mfma_f32_16x16x32_bf16 v[108:111], v[152:155], v[140:143], v[108:111]
    ds_read_b64_tr_b16 v[184:185], v24 offset:8192
    s_waitcnt lgkmcnt(9)
    v_mfma_f32_16x16x32_bf16 v[112:115], v[156:159], v[128:131], v[112:115]
    ds_read_b64_tr_b16 v[186:187], v24 offset:9216
    v_mfma_f32_16x16x32_bf16 v[116:119], v[156:159], v[132:135], v[116:119]
    buffer_load_dwordx4 v13, s[12:15], s89 offen offset:3072 lds
    v_mfma_f32_16x16x32_bf16 v[120:123], v[156:159], v[136:139], v[120:123]
    ds_read_b64_tr_b16 v[188:189], v25 offset:8192
    v_mfma_f32_16x16x32_bf16 v[124:127], v[156:159], v[140:143], v[124:127]
    ds_read_b64_tr_b16 v[190:191], v25 offset:9216
    s_add_u32 m0, s44, 32768
    s_waitcnt vmcnt(9)
    s_barrier
    s_waitcnt vmcnt(8)
    v_cmp_ne_u32 vcc, v28, v49
    s_waitcnt lgkmcnt(6)
    v_mfma_f32_16x16x32_bf16 v[64:67], v[176:179], v[160:163], v[64:67]
    ds_read_b128 v[128:131], v20 offset:32768
    v_mfma_f32_16x16x32_bf16 v[68:71], v[176:179], v[164:167], v[68:71]
    buffer_load_dwordx4 v6, s[8:11], s90 offen offset:0 lds
    v_mfma_f32_16x16x32_bf16 v[72:75], v[176:179], v[168:171], v[72:75]
    ds_read_b64_tr_b16 v[144:145], v22 offset:32768
    s_cmp_eq_u64 vcc, 0
    s_cselect_b32 s66, s54, 0x2000000
    s_cselect_b32 s67, s55, 0x2000000
    s_cselect_b32 s61, s56, 0x2000000
    s_cselect_b32 s97, 1, 0
    v_mfma_f32_16x16x32_bf16 v[76:79], v[176:179], v[172:175], v[76:79]
    ds_read_b64_tr_b16 v[146:147], v22 offset:33792
    s_waitcnt lgkmcnt(7)
    v_mfma_f32_16x16x32_bf16 v[80:83], v[180:183], v[160:163], v[80:83]
    ds_read_b128 v[132:135], v20 offset:34816
    v_mfma_f32_16x16x32_bf16 v[84:87], v[180:183], v[164:167], v[84:87]
    buffer_load_dwordx4 v7, s[8:11], s90 offen offset:1024 lds
    v_mfma_f32_16x16x32_bf16 v[88:91], v[180:183], v[168:171], v[88:91]
    ds_read_b128 v[136:139], v20 offset:36864
    v_mfma_f32_16x16x32_bf16 v[92:95], v[180:183], v[172:175], v[92:95]
    ds_read_b128 v[140:143], v20 offset:38912
    s_waitcnt lgkmcnt(8)
    v_mfma_f32_16x16x32_bf16 v[96:99], v[184:187], v[160:163], v[96:99]
    ds_read_b64_tr_b16 v[148:149], v23 offset:32768
    v_mfma_f32_16x16x32_bf16 v[100:103], v[184:187], v[164:167], v[100:103]
    buffer_load_dwordx4 v8, s[8:11], s90 offen offset:2048 lds
    v_mfma_f32_16x16x32_bf16 v[104:107], v[184:187], v[168:171], v[104:107]
    ds_read_b64_tr_b16 v[150:151], v23 offset:33792
    v_mfma_f32_16x16x32_bf16 v[108:111], v[184:187], v[172:175], v[108:111]
    ds_read_b64_tr_b16 v[152:153], v24 offset:32768
    s_waitcnt lgkmcnt(9)
    v_mfma_f32_16x16x32_bf16 v[112:115], v[188:191], v[160:163], v[112:115]
    ds_read_b64_tr_b16 v[154:155], v24 offset:33792
    v_mfma_f32_16x16x32_bf16 v[116:119], v[188:191], v[164:167], v[116:119]
    buffer_load_dwordx4 v9, s[8:11], s90 offen offset:3072 lds
    v_mfma_f32_16x16x32_bf16 v[120:123], v[188:191], v[168:171], v[120:123]
    ds_read_b64_tr_b16 v[156:157], v25 offset:32768
    v_mfma_f32_16x16x32_bf16 v[124:127], v[188:191], v[172:175], v[124:127]
    ds_read_b64_tr_b16 v[158:159], v25 offset:33792
    s_add_u32 m0, s44, 49152
    s_waitcnt lgkmcnt(6)
    v_mfma_f32_16x16x32_bf16 v[64:67], v[144:147], v[128:131], v[64:67]
    ds_read_b128 v[160:163], v21 offset:32768
    v_mfma_f32_16x16x32_bf16 v[68:71], v[144:147], v[132:135], v[68:71]
    buffer_load_dwordx4 v10, s[12:15], s91 offen offset:0 lds
    v_mfma_f32_16x16x32_bf16 v[72:75], v[144:147], v[136:139], v[72:75]
    ds_read_b64_tr_b16 v[176:177], v22 offset:40960
    v_mfma_f32_16x16x32_bf16 v[76:79], v[144:147], v[140:143], v[76:79]
    ds_read_b64_tr_b16 v[178:179], v22 offset:41984
    s_waitcnt lgkmcnt(7)
    v_mfma_f32_16x16x32_bf16 v[80:83], v[148:151], v[128:131], v[80:83]
    ds_read_b128 v[164:167], v21 offset:34816
    v_mfma_f32_16x16x32_bf16 v[84:87], v[148:151], v[132:135], v[84:87]
    buffer_load_dwordx4 v11, s[12:15], s91 offen offset:1024 lds
    v_mfma_f32_16x16x32_bf16 v[88:91], v[148:151], v[136:139], v[88:91]
    ds_read_b128 v[168:171], v21 offset:36864
    v_mfma_f32_16x16x32_bf16 v[92:95], v[148:151], v[140:143], v[92:95]
    ds_read_b128 v[172:175], v21 offset:38912
    s_waitcnt lgkmcnt(8)
    v_mfma_f32_16x16x32_bf16 v[96:99], v[152:155], v[128:131], v[96:99]
    ds_read_b64_tr_b16 v[180:181], v23 offset:40960
    v_mfma_f32_16x16x32_bf16 v[100:103], v[152:155], v[132:135], v[100:103]
    buffer_load_dwordx4 v12, s[12:15], s91 offen offset:2048 lds
    v_mfma_f32_16x16x32_bf16 v[104:107], v[152:155], v[136:139], v[104:107]
    ds_read_b64_tr_b16 v[182:183], v23 offset:41984
    v_mfma_f32_16x16x32_bf16 v[108:111], v[152:155], v[140:143], v[108:111]
    ds_read_b64_tr_b16 v[184:185], v24 offset:40960
    s_waitcnt lgkmcnt(9)
    v_mfma_f32_16x16x32_bf16 v[112:115], v[156:159], v[128:131], v[112:115]
    ds_read_b64_tr_b16 v[186:187], v24 offset:41984
    v_mfma_f32_16x16x32_bf16 v[116:119], v[156:159], v[132:135], v[116:119]
    buffer_load_dwordx4 v13, s[12:15], s91 offen offset:3072 lds
    v_mfma_f32_16x16x32_bf16 v[120:123], v[156:159], v[136:139], v[120:123]
    ds_read_b64_tr_b16 v[188:189], v25 offset:40960
    v_mfma_f32_16x16x32_bf16 v[124:127], v[156:159], v[140:143], v[124:127]
    ds_read_b64_tr_b16 v[190:191], v25 offset:41984
    s_waitcnt vmcnt(8)
    s_barrier
    s_waitcnt lgkmcnt(6)
    v_mfma_f32_16x16x32_bf16 v[64:67], v[176:179], v[160:163], v[64:67]
    ds_read_b128 v[128:131], v14 offset:0
    v_mfma_f32_16x16x32_bf16 v[68:71], v[176:179], v[164:167], v[68:71]
    buffer_load_dwordx4 a[0:3], v41, s[24:27], s66 offen offset:0 sc1
    v_mfma_f32_16x16x32_bf16 v[72:75], v[176:179], v[168:171], v[72:75]
    ds_read_b64_tr_b16 v[144:145], v16 offset:0
    v_mfma_f32_16x16x32_bf16 v[76:79], v[176:179], v[172:175], v[76:79]
    ds_read_b64_tr_b16 v[146:147], v16 offset:1024
    s_waitcnt lgkmcnt(7)
    v_mfma_f32_16x16x32_bf16 v[80:83], v[180:183], v[160:163], v[80:83]
    ds_read_b128 v[132:135], v14 offset:2048
    v_mfma_f32_16x16x32_bf16 v[84:87], v[180:183], v[164:167], v[84:87]
    buffer_load_dwordx4 a[4:7], v42, s[24:27], s66 offen offset:0 sc1
    v_mfma_f32_16x16x32_bf16 v[88:91], v[180:183], v[168:171], v[88:91]
    ds_read_b128 v[136:139], v14 offset:4096
    v_mfma_f32_16x16x32_bf16 v[92:95], v[180:183], v[172:175], v[92:95]
    ds_read_b128 v[140:143], v14 offset:6144
    s_waitcnt lgkmcnt(8)
    v_mfma_f32_16x16x32_bf16 v[96:99], v[184:187], v[160:163], v[96:99]
    ds_read_b64_tr_b16 v[148:149], v17 offset:0
    v_mfma_f32_16x16x32_bf16 v[100:103], v[184:187], v[164:167], v[100:103]
    buffer_load_dwordx4 a[8:11], v43, s[24:27], s66 offen offset:0 sc1
    v_mfma_f32_16x16x32_bf16 v[104:107], v[184:187], v[168:171], v[104:107]
    ds_read_b64_tr_b16 v[150:151], v17 offset:1024
    v_mfma_f32_16x16x32_bf16 v[108:111], v[184:187], v[172:175], v[108:111]
    ds_read_b64_tr_b16 v[152:153], v18 offset:0
    s_waitcnt lgkmcnt(9)
    v_mfma_f32_16x16x32_bf16 v[112:115], v[188:191], v[160:163], v[112:115]
    ds_read_b64_tr_b16 v[154:155], v18 offset:1024
    v_mfma_f32_16x16x32_bf16 v[116:119], v[188:191], v[164:167], v[116:119]
    buffer_load_dwordx4 a[12:15], v44, s[24:27], s66 offen offset:0 sc1
    v_mfma_f32_16x16x32_bf16 v[120:123], v[188:191], v[168:171], v[120:123]
    ds_read_b64_tr_b16 v[156:157], v19 offset:0
    v_mfma_f32_16x16x32_bf16 v[124:127], v[188:191], v[172:175], v[124:127]
    ds_read_b64_tr_b16 v[158:159], v19 offset:1024
    s_waitcnt lgkmcnt(6)
    v_mfma_f32_16x16x32_bf16 v[64:67], v[144:147], v[128:131], v[64:67]
    ds_read_b128 v[160:163], v15 offset:0
    v_mfma_f32_16x16x32_bf16 v[68:71], v[144:147], v[132:135], v[68:71]
    buffer_load_dwordx4 a[16:19], v45, s[24:27], s66 offen offset:0 sc1
    v_mfma_f32_16x16x32_bf16 v[72:75], v[144:147], v[136:139], v[72:75]
    ds_read_b64_tr_b16 v[176:177], v16 offset:8192
    v_mfma_f32_16x16x32_bf16 v[76:79], v[144:147], v[140:143], v[76:79]
    ds_read_b64_tr_b16 v[178:179], v16 offset:9216
    s_waitcnt lgkmcnt(7)
    v_mfma_f32_16x16x32_bf16 v[80:83], v[148:151], v[128:131], v[80:83]
    ds_read_b128 v[164:167], v15 offset:2048
    v_mfma_f32_16x16x32_bf16 v[84:87], v[148:151], v[132:135], v[84:87]
    buffer_load_dwordx4 a[20:23], v41, s[24:27], s66 offen offset:1024 sc1
    v_mfma_f32_16x16x32_bf16 v[88:91], v[148:151], v[136:139], v[88:91]
    ds_read_b128 v[168:171], v15 offset:4096
    v_mfma_f32_16x16x32_bf16 v[92:95], v[148:151], v[140:143], v[92:95]
    ds_read_b128 v[172:175], v15 offset:6144
    s_waitcnt lgkmcnt(8)
    v_mfma_f32_16x16x32_bf16 v[96:99], v[152:155], v[128:131], v[96:99]
    ds_read_b64_tr_b16 v[180:181], v17 offset:8192
    v_mfma_f32_16x16x32_bf16 v[100:103], v[152:155], v[132:135], v[100:103]
    buffer_load_dwordx4 a[24:27], v42, s[24:27], s66 offen offset:1024 sc1
    v_mfma_f32_16x16x32_bf16 v[104:107], v[152:155], v[136:139], v[104:107]
    ds_read_b64_tr_b16 v[182:183], v17 offset:9216
    v_mfma_f32_16x16x32_bf16 v[108:111], v[152:155], v[140:143], v[108:111]
    ds_read_b64_tr_b16 v[184:185], v18 offset:8192
    s_waitcnt lgkmcnt(9)
    v_mfma_f32_16x16x32_bf16 v[112:115], v[156:159], v[128:131], v[112:115]
    ds_read_b64_tr_b16 v[186:187], v18 offset:9216
    v_mfma_f32_16x16x32_bf16 v[116:119], v[156:159], v[132:135], v[116:119]
    buffer_load_dwordx4 a[28:31], v43, s[24:27], s66 offen offset:1024 sc1
    v_mfma_f32_16x16x32_bf16 v[120:123], v[156:159], v[136:139], v[120:123]
    ds_read_b64_tr_b16 v[188:189], v19 offset:8192
    v_mfma_f32_16x16x32_bf16 v[124:127], v[156:159], v[140:143], v[124:127]
    ds_read_b64_tr_b16 v[190:191], v19 offset:9216
    s_waitcnt lgkmcnt(6)
    v_mfma_f32_16x16x32_bf16 v[64:67], v[176:179], v[160:163], v[64:67]
    v_mfma_f32_16x16x32_bf16 v[68:71], v[176:179], v[164:167], v[68:71]
    buffer_load_dwordx4 a[32:35], v44, s[24:27], s66 offen offset:1024 sc1
    v_mfma_f32_16x16x32_bf16 v[72:75], v[176:179], v[168:171], v[72:75]
    v_mfma_f32_16x16x32_bf16 v[76:79], v[176:179], v[172:175], v[76:79]
    s_waitcnt lgkmcnt(4)
    v_mfma_f32_16x16x32_bf16 v[80:83], v[180:183], v[160:163], v[80:83]
    v_mfma_f32_16x16x32_bf16 v[84:87], v[180:183], v[164:167], v[84:87]
    buffer_load_dwordx4 a[36:39], v45, s[24:27], s66 offen offset:1024 sc1
    v_mfma_f32_16x16x32_bf16 v[88:91], v[180:183], v[168:171], v[88:91]
    v_mfma_f32_16x16x32_bf16 v[92:95], v[180:183], v[172:175], v[92:95]
    s_waitcnt vmcnt(10)
    s_barrier
    s_waitcnt lgkmcnt(2)
    v_mfma_f32_16x16x32_bf16 v[96:99], v[184:187], v[160:163], v[96:99]
    ds_read_b128 v[128:131], v14 offset:32768
    ds_read_b64_tr_b16 v[144:145], v16 offset:32768
    v_mfma_f32_16x16x32_bf16 v[100:103], v[184:187], v[164:167], v[100:103]
    buffer_load_dwordx4 a[40:43], v41, s[24:27], s66 offen offset:2048 sc1
    ds_read_b64_tr_b16 v[146:147], v16 offset:33792
    v_mfma_f32_16x16x32_bf16 v[104:107], v[184:187], v[168:171], v[104:107]
    ds_read_b64_tr_b16 v[148:149], v17 offset:32768
    ds_read_b64_tr_b16 v[150:151], v17 offset:33792
    v_mfma_f32_16x16x32_bf16 v[108:111], v[184:187], v[172:175], v[108:111]
    ds_read_b128 v[132:135], v14 offset:34816
    ds_read_b128 v[136:139], v14 offset:36864
    s_waitcnt lgkmcnt(7)
    v_mfma_f32_16x16x32_bf16 v[112:115], v[188:191], v[160:163], v[112:115]
    ds_read_b128 v[140:143], v14 offset:38912
    ds_read_b64_tr_b16 v[152:153], v18 offset:32768
    v_mfma_f32_16x16x32_bf16 v[116:119], v[188:191], v[164:167], v[116:119]
    buffer_load_dwordx4 a[44:47], v42, s[24:27], s66 offen offset:2048 sc1
    ds_read_b64_tr_b16 v[154:155], v18 offset:33792
    v_mfma_f32_16x16x32_bf16 v[120:123], v[188:191], v[168:171], v[120:123]
    ds_read_b64_tr_b16 v[156:157], v19 offset:32768
    ds_read_b64_tr_b16 v[158:159], v19 offset:33792
    v_mfma_f32_16x16x32_bf16 v[124:127], v[188:191], v[172:175], v[124:127]
    s_waitcnt lgkmcnt(9)
    v_mfma_f32_16x16x32_bf16 v[64:67], v[144:147], v[128:131], v[64:67]
    ds_read_b128 v[160:163], v15 offset:32768
    ds_read_b64_tr_b16 v[176:177], v16 offset:40960
    s_waitcnt lgkmcnt(9)
    v_mfma_f32_16x16x32_bf16 v[80:83], v[148:151], v[128:131], v[80:83]
    ds_read_b64_tr_b16 v[178:179], v16 offset:41984
    buffer_load_dwordx4 a[48:51], v43, s[24:27], s66 offen offset:2048 sc1
    s_waitcnt lgkmcnt(9)
    v_mfma_f32_16x16x32_bf16 v[68:71], v[144:147], v[132:135], v[68:71]
    ds_read_b64_tr_b16 v[180:181], v17 offset:40960
    ds_read_b64_tr_b16 v[182:183], v17 offset:41984
    v_mfma_f32_16x16x32_bf16 v[84:87], v[148:151], v[132:135], v[84:87]
    ds_read_b128 v[164:167], v15 offset:34816
    ds_read_b128 v[168:171], v15 offset:36864
    s_waitcnt lgkmcnt(12)
    v_mfma_f32_16x16x32_bf16 v[72:75], v[144:147], v[136:139], v[72:75]
    ds_read_b128 v[172:175], v15 offset:38912
    ds_read_b64_tr_b16 v[184:185], v18 offset:40960
    v_mfma_f32_16x16x32_bf16 v[88:91], v[148:151], v[136:139], v[88:91]
    ds_read_b64_tr_b16 v[186:187], v18 offset:41984
    buffer_load_dwordx4 a[52:55], v44, s[24:27], s66 offen offset:2048 sc1
    s_waitcnt lgkmcnt(14)
    v_mfma_f32_16x16x32_bf16 v[76:79], v[144:147], v[140:143], v[76:79]
    ds_read_b64_tr_b16 v[188:189], v19 offset:40960
    ds_read_b64_tr_b16 v[190:191], v19 offset:41984
    v_mfma_f32_16x16x32_bf16 v[92:95], v[148:151], v[140:143], v[92:95]
    s_waitcnt lgkmcnt(9)
    v_mfma_f32_16x16x32_bf16 v[64:67], v[176:179], v[160:163], v[64:67]
    s_waitcnt lgkmcnt(7)
    v_mfma_f32_16x16x32_bf16 v[80:83], v[180:183], v[160:163], v[80:83]
    buffer_load_dwordx4 a[56:59], v45, s[24:27], s66 offen offset:2048 sc1
    s_waitcnt lgkmcnt(6)
    v_mfma_f32_16x16x32_bf16 v[68:71], v[176:179], v[164:167], v[68:71]
    v_mfma_f32_16x16x32_bf16 v[84:87], v[180:183], v[164:167], v[84:87]
    s_waitcnt lgkmcnt(5)
    v_mfma_f32_16x16x32_bf16 v[72:75], v[176:179], v[168:171], v[72:75]
    v_mfma_f32_16x16x32_bf16 v[88:91], v[180:183], v[168:171], v[88:91]
    buffer_load_dwordx4 a[60:63], v41, s[24:27], s67 offen offset:0 sc1
    s_waitcnt lgkmcnt(4)
    v_mfma_f32_16x16x32_bf16 v[76:79], v[176:179], v[172:175], v[76:79]
    v_mfma_f32_16x16x32_bf16 v[92:95], v[180:183], v[172:175], v[92:95]
    v_mfma_f32_16x16x32_bf16 v[96:99], v[152:155], v[128:131], v[96:99]
    v_mfma_f32_16x16x32_bf16 v[112:115], v[156:159], v[128:131], v[112:115]
    buffer_load_dwordx4 a[64:67], v42, s[24:27], s67 offen offset:0 sc1
    v_cvt_pk_bf16_f32 v192, v64, v65
    v_cvt_pk_bf16_f32 v193, v66, v67
    v_mfma_f32_16x16x32_bf16 v[100:103], v[152:155], v[132:135], v[100:103]
    v_cvt_pk_bf16_f32 v194, v80, v81
    v_cvt_pk_bf16_f32 v195, v82, v83
    v_pk_max_i16 v192, v192, 0
    v_mfma_f32_16x16x32_bf16 v[116:119], v[156:159], v[132:135], v[116:119]
    v_pk_max_i16 v193, v193, 0
    v_pk_max_i16 v194, v194, 0
    v_pk_max_i16 v195, v195, 0
    v_mfma_f32_16x16x32_bf16 v[104:107], v[152:155], v[136:139], v[104:107]
    v_or_b32 v192, s59, v192
    v_or_b32 v193, s62, v193
    v_or_b32 v194, s99, v194
    v_mfma_f32_16x16x32_bf16 v[120:123], v[156:159], v[136:139], v[120:123]
    buffer_load_dwordx4 a[68:71], v43, s[24:27], s67 offen offset:0 sc1
    v_or_b32 v195, s100, v195
    buffer_store_dwordx4 v[192:195], v31, s[24:27], s60 offen sc1
    v_mfma_f32_16x16x32_bf16 v[108:111], v[152:155], v[140:143], v[108:111]
    v_cvt_pk_bf16_f32 v196, v68, v69
    v_cvt_pk_bf16_f32 v197, v70, v71
    v_cvt_pk_bf16_f32 v198, v84, v85
    v_mfma_f32_16x16x32_bf16 v[124:127], v[156:159], v[140:143], v[124:127]
    v_cvt_pk_bf16_f32 v199, v86, v87
    v_pk_max_i16 v196, v196, 0
    v_pk_max_i16 v197, v197, 0
    s_waitcnt lgkmcnt(2)
    v_mfma_f32_16x16x32_bf16 v[96:99], v[184:187], v[160:163], v[96:99]
    v_pk_max_i16 v198, v198, 0
    v_pk_max_i16 v199, v199, 0
    v_or_b32 v196, s59, v196
    s_waitcnt lgkmcnt(0)
    v_mfma_f32_16x16x32_bf16 v[112:115], v[188:191], v[160:163], v[112:115]
    buffer_load_dwordx4 a[72:75], v44, s[24:27], s67 offen offset:0 sc1
    v_or_b32 v197, s62, v197
    v_or_b32 v198, s99, v198
    v_mfma_f32_16x16x32_bf16 v[100:103], v[184:187], v[164:167], v[100:103]
    v_or_b32 v199, s100, v199
    buffer_store_dwordx4 v[196:199], v26, s[24:27], s60 offen sc1
    v_cvt_pk_bf16_f32 v200, v72, v73
    v_mfma_f32_16x16x32_bf16 v[116:119], v[188:191], v[164:167], v[116:119]
    v_cvt_pk_bf16_f32 v201, v74, v75
    v_cvt_pk_bf16_f32 v202, v88, v89
    v_cvt_pk_bf16_f32 v203, v90, v91
    v_mfma_f32_16x16x32_bf16 v[104:107], v[184:187], v[168:171], v[104:107]
    v_pk_max_i16 v200, v200, 0
    v_pk_max_i16 v201, v201, 0
    v_pk_max_i16 v202, v202, 0
    v_mfma_f32_16x16x32_bf16 v[120:123], v[188:191], v[168:171], v[120:123]
    buffer_load_dwordx4 a[76:79], v45, s[24:27], s67 offen offset:0 sc1
    v_pk_max_i16 v203, v203, 0
    v_or_b32 v200, s59, v200
    v_mfma_f32_16x16x32_bf16 v[108:111], v[184:187], v[172:175], v[108:111]
    v_or_b32 v201, s62, v201
    v_or_b32 v202, s99, v202
    v_or_b32 v203, s100, v203
    v_mfma_f32_16x16x32_bf16 v[124:127], v[188:191], v[172:175], v[124:127]
    buffer_store_dwordx4 v[200:203], v27, s[24:27], s60 offen sc1
    v_cvt_pk_bf16_f32 v204, v76, v77
    v_cvt_pk_bf16_f32 v205, v78, v79
    v_cvt_pk_bf16_f32 v206, v92, v93
    v_cvt_pk_bf16_f32 v207, v94, v95
    v_pk_max_i16 v204, v204, 0
    v_pk_max_i16 v205, v205, 0
    v_pk_max_i16 v206, v206, 0
    v_pk_max_i16 v207, v207, 0
    v_or_b32 v204, s59, v204
    v_or_b32 v205, s62, v205
    v_or_b32 v206, s99, v206
    v_or_b32 v207, s100, v207
    buffer_store_dwordx4 v[204:207], v61, s[24:27], s60 offen sc1
    v_cvt_pk_bf16_f32 v208, v96, v97
    v_cvt_pk_bf16_f32 v209, v98, v99
    v_cvt_pk_bf16_f32 v210, v112, v113
    v_cvt_pk_bf16_f32 v211, v114, v115
    v_pk_max_i16 v208, v208, 0
    v_pk_max_i16 v209, v209, 0
    v_pk_max_i16 v210, v210, 0
    v_pk_max_i16 v211, v211, 0
    v_or_b32 v208, s59, v208
    v_or_b32 v209, s62, v209
    v_or_b32 v210, s99, v210
    v_or_b32 v211, s100, v211
    buffer_store_dwordx4 v[208:211], v31, s[24:27], s46 offen sc1
    v_cvt_pk_bf16_f32 v212, v100, v101
    v_cvt_pk_bf16_f32 v213, v102, v103
    v_cvt_pk_bf16_f32 v214, v116, v117
    v_cvt_pk_bf16_f32 v215, v118, v119
    v_pk_max_i16 v212, v212, 0
    v_pk_max_i16 v213, v213, 0
    v_pk_max_i16 v214, v214, 0
    v_pk_max_i16 v215, v215, 0
    v_or_b32 v212, s59, v212
    v_or_b32 v213, s62, v213
    v_or_b32 v214, s99, v214
    v_or_b32 v215, s100, v215
    buffer_store_dwordx4 v[212:215], v26, s[24:27], s46 offen sc1
    v_cvt_pk_bf16_f32 v216, v104, v105
    v_cvt_pk_bf16_f32 v217, v106, v107
    v_cvt_pk_bf16_f32 v218, v120, v121
    v_cvt_pk_bf16_f32 v219, v122, v123
    v_pk_max_i16 v216, v216, 0
    v_pk_max_i16 v217, v217, 0
    v_pk_max_i16 v218, v218, 0
    v_pk_max_i16 v219, v219, 0
    v_or_b32 v216, s59, v216
    v_or_b32 v217, s62, v217
    v_or_b32 v218, s99, v218
    v_or_b32 v219, s100, v219
    buffer_store_dwordx4 v[216:219], v27, s[24:27], s46 offen sc1
    v_cvt_pk_bf16_f32 v220, v108, v109
    v_cvt_pk_bf16_f32 v221, v110, v111
    v_cvt_pk_bf16_f32 v222, v124, v125
    v_cvt_pk_bf16_f32 v223, v126, v127
    v_pk_max_i16 v220, v220, 0
    v_pk_max_i16 v221, v221, 0
    v_pk_max_i16 v222, v222, 0
    v_pk_max_i16 v223, v223, 0
    v_or_b32 v220, s59, v220
    v_or_b32 v221, s62, v221
    v_or_b32 v222, s99, v222
    v_or_b32 v223, s100, v223
    buffer_store_dwordx4 v[220:223], v61, s[24:27], s46 offen sc1
    s_mov_b64 exec, 1
    buffer_store_dword v28, v32, s[24:27], 0 offen sc1
    s_mov_b64 exec, -1
    s_barrier
    s_cmp_lg_u32 s97, 1
    s_cbranch_scc1 L_w2wait
    buffer_load_dwordx4 a[80:83], v41, s[24:27], s55 offen offset:1024 sc1
    buffer_load_dwordx4 a[84:87], v42, s[24:27], s55 offen offset:1024 sc1
    buffer_load_dwordx4 a[88:91], v43, s[24:27], s55 offen offset:1024 sc1
    buffer_load_dwordx4 a[92:95], v44, s[24:27], s55 offen offset:1024 sc1
    buffer_load_dwordx4 a[96:99], v45, s[24:27], s55 offen offset:1024 sc1
    buffer_load_dwordx4 a[100:103], v41, s[24:27], s55 offen offset:2048 sc1
    buffer_load_dwordx4 a[104:107], v42, s[24:27], s55 offen offset:2048 sc1
    buffer_load_dwordx4 a[108:111], v43, s[24:27], s55 offen offset:2048 sc1
    buffer_load_dwordx4 a[112:115], v44, s[24:27], s55 offen offset:2048 sc1
    buffer_load_dwordx4 a[116:119], v45, s[24:27], s55 offen offset:2048 sc1
    buffer_load_dwordx4 a[120:123], v41, s[24:27], s56 offen offset:0 sc1
    buffer_load_dwordx4 a[124:127], v42, s[24:27], s56 offen offset:0 sc1
    buffer_load_dwordx4 a[128:131], v43, s[24:27], s56 offen offset:0 sc1
    buffer_load_dwordx4 a[132:135], v44, s[24:27], s56 offen offset:0 sc1
    buffer_load_dwordx4 a[136:139], v45, s[24:27], s56 offen offset:0 sc1
    buffer_load_dwordx4 a[140:143], v41, s[24:27], s56 offen offset:1024 sc1
    buffer_load_dwordx4 a[144:147], v42, s[24:27], s56 offen offset:1024 sc1
    buffer_load_dwordx4 a[148:151], v43, s[24:27], s56 offen offset:1024 sc1
    buffer_load_dwordx4 a[152:155], v44, s[24:27], s56 offen offset:1024 sc1
    buffer_load_dwordx4 a[156:159], v45, s[24:27], s56 offen offset:1024 sc1
    buffer_load_dwordx4 a[160:163], v41, s[24:27], s56 offen offset:2048 sc1
    buffer_load_dwordx4 a[164:167], v42, s[24:27], s56 offen offset:2048 sc1
    buffer_load_dwordx4 a[168:171], v43, s[24:27], s56 offen offset:2048 sc1
    buffer_load_dwordx4 a[172:175], v44, s[24:27], s56 offen offset:2048 sc1
    s_load_dwordx8 s[72:79], s[24:25], s63 glc
    buffer_load_dwordx4 a[176:179], v45, s[24:27], s56 offen offset:2048 sc1
    buffer_load_dwordx4 a[180:183], v41, s[24:27], s57 offen offset:0 sc1
    buffer_load_dwordx4 a[184:187], v42, s[24:27], s57 offen offset:0 sc1
    buffer_load_dwordx4 a[188:191], v43, s[24:27], s57 offen offset:0 sc1
    buffer_load_dwordx4 a[192:195], v44, s[24:27], s57 offen offset:0 sc1
    buffer_load_dwordx4 a[196:199], v45, s[24:27], s57 offen offset:0 sc1
    s_waitcnt lgkmcnt(0)
    s_xor_b64 s[72:73], s[72:73], s[70:71]
    s_xor_b64 s[74:75], s[74:75], s[70:71]
    s_xor_b64 s[76:77], s[76:77], s[70:71]
    s_or_b64 s[72:73], s[72:73], s[74:75]
    s_or_b64 s[72:73], s[72:73], s[76:77]
    s_cbranch_scc1 L_late
    v_mov_b32 v58, 0
    buffer_load_dwordx4 v[64:67], v37, s[24:27], s50 offen offset:0 sc1
    buffer_load_dwordx4 v[68:71], v37, s[24:27], s50 offen offset:1024 sc1
    buffer_load_dwordx4 v[72:75], v37, s[24:27], s50 offen offset:2048 sc1
    buffer_load_dwordx4 v[76:79], v37, s[24:27], s51 offen offset:0 sc1
    buffer_load_dwordx4 v[80:83], v37, s[24:27], s51 offen offset:1024 sc1
    buffer_load_dwordx4 a[200:203], v41, s[24:27], s57 offen offset:1024 sc1
    buffer_load_dwordx4 a[204:207], v42, s[24:27], s57 offen offset:1024 sc1
    buffer_load_dwordx4 a[208:211], v43, s[24:27], s57 offen offset:1024 sc1
    buffer_load_dwordx4 a[212:215], v44, s[24:27], s57 offen offset:1024 sc1
    buffer_load_dwordx4 a[216:219], v45, s[24:27], s57 offen offset:1024 sc1
    buffer_load_dwordx4 v[84:87], v37, s[24:27], s51 offen offset:2048 sc1
    buffer_load_dwordx4 v[88:91], v37, s[24:27], s52 offen offset:0 sc1
    s_waitcnt vmcnt(11)
    v_mfma_f32_16x16x32_bf16 v[128:131], a[0:3], v[64:67], 0
    buffer_load_dwordx4 v[92:95], v37, s[24:27], s52 offen offset:1024 sc1
    v_mfma_f32_16x16x32_bf16 v[132:135], a[4:7], v[64:67], 0
    v_bitop3_b32 v58, v58, v64, s59 bitop3:0xf6
    v_mfma_f32_16x16x32_bf16 v[136:139], a[8:11], v[64:67], 0
    v_bitop3_b32 v58, v58, v65, s62 bitop3:0xf6
    v_mfma_f32_16x16x32_bf16 v[140:143], a[12:15], v[64:67], 0
    v_bitop3_b32 v58, v58, v66, s99 bitop3:0xf6
    v_mfma_f32_16x16x32_bf16 v[144:147], a[16:19], v[64:67], 0
    v_bitop3_b32 v58, v58, v67, s100 bitop3:0xf6
    s_waitcnt vmcnt(11)
    v_mfma_f32_16x16x32_bf16 v[128:131], a[20:23], v[68:71], v[128:131]
    buffer_load_dwordx4 v[96:99], v37, s[24:27], s52 offen offset:2048 sc1
    v_mfma_f32_16x16x32_bf16 v[132:135], a[24:27], v[68:71], v[132:135]
    v_bitop3_b32 v58, v58, v68, s59 bitop3:0xf6
    v_mfma_f32_16x16x32_bf16 v[136:139], a[28:31], v[68:71], v[136:139]
    v_bitop3_b32 v58, v58, v69, s62 bitop3:0xf6
    v_mfma_f32_16x16x32_bf16 v[140:143], a[32:35], v[68:71], v[140:143]
    v_bitop3_b32 v58, v58, v70, s99 bitop3:0xf6
    v_mfma_f32_16x16x32_bf16 v[144:147], a[36:39], v[68:71], v[144:147]
    v_bitop3_b32 v58, v58, v71, s100 bitop3:0xf6
    s_waitcnt vmcnt(11)
    v_mfma_f32_16x16x32_bf16 v[128:131], a[40:43], v[72:75], v[128:131]
    buffer_load_dwordx4 a[220:223], v41, s[24:27], s57 offen offset:2048 sc1
    v_mfma_f32_16x16x32_bf16 v[132:135], a[44:47], v[72:75], v[132:135]
    v_bitop3_b32 v58, v58, v72, s59 bitop3:0xf6
    v_mfma_f32_16x16x32_bf16 v[136:139], a[48:51], v[72:75], v[136:139]
    v_bitop3_b32 v58, v58, v73, s62 bitop3:0xf6
    v_mfma_f32_16x16x32_bf16 v[140:143], a[52:55], v[72:75], v[140:143]
    v_bitop3_b32 v58, v58, v74, s99 bitop3:0xf6
    v_mfma_f32_16x16x32_bf16 v[144:147], a[56:59], v[72:75], v[144:147]
    v_bitop3_b32 v58, v58, v75, s100 bitop3:0xf6
    s_waitcnt vmcnt(11)
    v_mfma_f32_16x16x32_bf16 v[128:131], a[60:63], v[76:79], v[128:131]
    buffer_load_dwordx4 a[224:227], v42, s[24:27], s57 offen offset:2048 sc1
    v_mfma_f32_16x16x32_bf16 v[132:135], a[64:67], v[76:79], v[132:135]
    v_bitop3_b32 v58, v58, v76, s59 bitop3:0xf6
    v_mfma_f32_16x16x32_bf16 v[136:139], a[68:71], v[76:79], v[136:139]
    v_bitop3_b32 v58, v58, v77, s62 bitop3:0xf6
    v_mfma_f32_16x16x32_bf16 v[140:143], a[72:75], v[76:79], v[140:143]
    v_bitop3_b32 v58, v58, v78, s99 bitop3:0xf6
    v_mfma_f32_16x16x32_bf16 v[144:147], a[76:79], v[76:79], v[144:147]
    v_bitop3_b32 v58, v58, v79, s100 bitop3:0xf6
    s_waitcnt vmcnt(11)
    v_mfma_f32_16x16x32_bf16 v[128:131], a[80:83], v[80:83], v[128:131]
    buffer_load_dwordx4 a[228:231], v43, s[24:27], s57 offen offset:2048 sc1
    buffer_load_dwordx4 a[232:235], v44, s[24:27], s57 offen offset:2048 sc1
    v_mfma_f32_16x16x32_bf16 v[132:135], a[84:87], v[80:83], v[132:135]
    buffer_load_dwordx4 a[236:239], v45, s[24:27], s57 offen offset:2048 sc1
    v_bitop3_b32 v58, v58, v80, s59 bitop3:0xf6
    v_mfma_f32_16x16x32_bf16 v[136:139], a[88:91], v[80:83], v[136:139]
    buffer_load_dwordx4 v[100:103], v37, s[24:27], s53 offen offset:0 sc1
    v_bitop3_b32 v58, v58, v81, s62 bitop3:0xf6
    v_mfma_f32_16x16x32_bf16 v[140:143], a[92:95], v[80:83], v[140:143]
    buffer_load_dwordx4 v[104:107], v37, s[24:27], s53 offen offset:1024 sc1
    v_bitop3_b32 v58, v58, v82, s99 bitop3:0xf6
    v_mfma_f32_16x16x32_bf16 v[144:147], a[96:99], v[80:83], v[144:147]
    buffer_load_dwordx4 v[108:111], v37, s[24:27], s53 offen offset:2048 sc1
    v_bitop3_b32 v58, v58, v83, s100 bitop3:0xf6
    s_waitcnt vmcnt(11)
    v_mfma_f32_16x16x32_bf16 v[128:131], a[100:103], v[84:87], v[128:131]
    buffer_load_dwordx4 v[112:115], v38, s[24:27], s50 offen offset:0 sc1
    v_mfma_f32_16x16x32_bf16 v[132:135], a[104:107], v[84:87], v[132:135]
    v_bitop3_b32 v58, v58, v84, s59 bitop3:0xf6
    v_mfma_f32_16x16x32_bf16 v[136:139], a[108:111], v[84:87], v[136:139]
    v_bitop3_b32 v58, v58, v85, s62 bitop3:0xf6
    v_mfma_f32_16x16x32_bf16 v[140:143], a[112:115], v[84:87], v[140:143]
    v_bitop3_b32 v58, v58, v86, s99 bitop3:0xf6
    v_mfma_f32_16x16x32_bf16 v[144:147], a[116:119], v[84:87], v[144:147]
    v_bitop3_b32 v58, v58, v87, s100 bitop3:0xf6
    s_waitcnt vmcnt(11)
    v_mfma_f32_16x16x32_bf16 v[128:131], a[120:123], v[88:91], v[128:131]
    buffer_load_dwordx4 v[116:119], v38, s[24:27], s50 offen offset:1024 sc1
    v_mfma_f32_16x16x32_bf16 v[132:135], a[124:127], v[88:91], v[132:135]
    v_bitop3_b32 v58, v58, v88, s59 bitop3:0xf6
    v_mfma_f32_16x16x32_bf16 v[136:139], a[128:131], v[88:91], v[136:139]
    v_bitop3_b32 v58, v58, v89, s62 bitop3:0xf6
    v_mfma_f32_16x16x32_bf16 v[140:143], a[132:135], v[88:91], v[140:143]
    v_bitop3_b32 v58, v58, v90, s99 bitop3:0xf6
    v_mfma_f32_16x16x32_bf16 v[144:147], a[136:139], v[88:91], v[144:147]
    v_bitop3_b32 v58, v58, v91, s100 bitop3:0xf6
    s_waitcnt vmcnt(11)
    v_mfma_f32_16x16x32_bf16 v[128:131], a[140:143], v[92:95], v[128:131]
    buffer_load_dwordx4 v[120:123], v38, s[24:27], s50 offen offset:2048 sc1
    v_mfma_f32_16x16x32_bf16 v[132:135], a[144:147], v[92:95], v[132:135]
    v_bitop3_b32 v58, v58, v92, s59 bitop3:0xf6
    v_mfma_f32_16x16x32_bf16 v[136:139], a[148:151], v[92:95], v[136:139]
    v_bitop3_b32 v58, v58, v93, s62 bitop3:0xf6
    v_mfma_f32_16x16x32_bf16 v[140:143], a[152:155], v[92:95], v[140:143]
    v_bitop3_b32 v58, v58, v94, s99 bitop3:0xf6
    v_mfma_f32_16x16x32_bf16 v[144:147], a[156:159], v[92:95], v[144:147]
    v_bitop3_b32 v58, v58, v95, s100 bitop3:0xf6
    s_waitcnt vmcnt(11)
    v_and_b32 v59, 0x80008000, v58
    v_cmp_ne_u32 vcc, 0, v59
    s_cbranch_vccnz L_restart
    v_mfma_f32_16x16x32_bf16 v[128:131], a[160:163], v[96:99], v[128:131]
    buffer_load_dwordx4 v[124:127], v38, s[24:27], s51 offen offset:0 sc1
    buffer_load_dwordx4 v[64:67], v38, s[24:27], s51 offen offset:1024 sc1
    v_mfma_f32_16x16x32_bf16 v[132:135], a[164:167], v[96:99], v[132:135]
    buffer_load_dwordx4 v[68:71], v38, s[24:27], s51 offen offset:2048 sc1
    v_bitop3_b32 v58, v58, v96, s59 bitop3:0xf6
    v_mfma_f32_16x16x32_bf16 v[136:139], a[168:171], v[96:99], v[136:139]
    buffer_load_dwordx4 v[72:75], v38, s[24:27], s52 offen offset:0 sc1
    v_bitop3_b32 v58, v58, v97, s62 bitop3:0xf6
    v_mfma_f32_16x16x32_bf16 v[140:143], a[172:175], v[96:99], v[140:143]
    buffer_load_dwordx4 v[76:79], v38, s[24:27], s52 offen offset:1024 sc1
    v_bitop3_b32 v58, v58, v98, s99 bitop3:0xf6
    v_mfma_f32_16x16x32_bf16 v[144:147], a[176:179], v[96:99], v[144:147]
    buffer_load_dwordx4 v[80:83], v38, s[24:27], s52 offen offset:2048 sc1
    v_bitop3_b32 v58, v58, v99, s100 bitop3:0xf6
    s_waitcnt vmcnt(11)
    v_mfma_f32_16x16x32_bf16 v[128:131], a[180:183], v[100:103], v[128:131]
    buffer_load_dwordx4 v[84:87], v38, s[24:27], s53 offen offset:0 sc1
    v_mfma_f32_16x16x32_bf16 v[132:135], a[184:187], v[100:103], v[132:135]
    v_bitop3_b32 v58, v58, v100, s59 bitop3:0xf6
    v_mfma_f32_16x16x32_bf16 v[136:139], a[188:191], v[100:103], v[136:139]
    v_bitop3_b32 v58, v58, v101, s62 bitop3:0xf6
    v_mfma_f32_16x16x32_bf16 v[140:143], a[192:195], v[100:103], v[140:143]
    v_bitop3_b32 v58, v58, v102, s99 bitop3:0xf6
    v_mfma_f32_16x16x32_bf16 v[144:147], a[196:199], v[100:103], v[144:147]
    v_bitop3_b32 v58, v58, v103, s100 bitop3:0xf6
    s_waitcnt vmcnt(11)
    v_mfma_f32_16x16x32_bf16 v[128:131], a[200:203], v[104:107], v[128:131]
    buffer_load_dwordx4 v[88:91], v38, s[24:27], s53 offen offset:1024 sc1
    v_mfma_f32_16x16x32_bf16 v[132:135], a[204:207], v[104:107], v[132:135]
    v_bitop3_b32 v58, v58, v104, s59 bitop3:0xf6
    v_mfma_f32_16x16x32_bf16 v[136:139], a[208:211], v[104:107], v[136:139]
    v_bitop3_b32 v58, v58, v105, s62 bitop3:0xf6
    v_mfma_f32_16x16x32_bf16 v[140:143], a[212:215], v[104:107], v[140:143]
    v_bitop3_b32 v58, v58, v106, s99 bitop3:0xf6
    v_mfma_f32_16x16x32_bf16 v[144:147], a[216:219], v[104:107], v[144:147]
    v_bitop3_b32 v58, v58, v107, s100 bitop3:0xf6
    s_waitcnt vmcnt(11)
    v_mfma_f32_16x16x32_bf16 v[128:131], a[220:223], v[108:111], v[128:131]
    buffer_load_dwordx4 v[92:95], v38, s[24:27], s53 offen offset:2048 sc1
    v_mfma_f32_16x16x32_bf16 v[132:135], a[224:227], v[108:111], v[132:135]
    v_bitop3_b32 v58, v58, v108, s59 bitop3:0xf6
    v_mfma_f32_16x16x32_bf16 v[136:139], a[228:231], v[108:111], v[136:139]
    v_bitop3_b32 v58, v58, v109, s62 bitop3:0xf6
    v_mfma_f32_16x16x32_bf16 v[140:143], a[232:235], v[108:111], v[140:143]
    v_bitop3_b32 v58, v58, v110, s99 bitop3:0xf6
    v_mfma_f32_16x16x32_bf16 v[144:147], a[236:239], v[108:111], v[144:147]
    v_bitop3_b32 v58, v58, v111, s100 bitop3:0xf6
    s_branch L_j12
L_late:
    buffer_load_dwordx4 a[200:203], v41, s[24:27], s57 offen offset:1024 sc1
    buffer_load_dwordx4 a[204:207], v42, s[24:27], s57 offen offset:1024 sc1
    buffer_load_dwordx4 a[208:211], v43, s[24:27], s57 offen offset:1024 sc1
    buffer_load_dwordx4 a[212:215], v44, s[24:27], s57 offen offset:1024 sc1
    s_load_dwordx8 s[72:79], s[24:25], s63 glc
    buffer_load_dwordx4 a[216:219], v45, s[24:27], s57 offen offset:1024 sc1
    buffer_load_dwordx4 a[220:223], v41, s[24:27], s57 offen offset:2048 sc1
    buffer_load_dwordx4 a[224:227], v42, s[24:27], s57 offen offset:2048 sc1
    buffer_load_dwordx4 a[228:231], v43, s[24:27], s57 offen offset:2048 sc1
    buffer_load_dwordx4 a[232:235], v44, s[24:27], s57 offen offset:2048 sc1
    buffer_load_dwordx4 a[236:239], v45, s[24:27], s57 offen offset:2048 sc1
    s_branch L_join
L_spare:
    s_lshl_b32 s39, s29, 3
    s_and_b32 s40, s30, 7
    s_add_u32 s39, s39, s40
    s_lshl_b32 s39, s39, 2
    s_add_u32 s39, s39, s28
    s_cmp_ge_u32 s39, 240
    s_cselect_b32 s40, 240, 0
    s_sub_u32 s39, s39, s40
    s_mul_i32 s46, s39, 205
    s_lshr_b32 s46, s46, 11
    s_mul_i32 s40, s46, 10
    s_sub_u32 s47, s39, s40
    s_mul_i32 s68, s46, 81920
    s_lshl_b32 s40, s47, 7
    s_add_u32 s68, s68, s40
    v_lshl_add_u32 v6, v4, 4, v2
    v_add_u32 v7, 9216, v6
    v_add_u32 v8, 18432, v6
    v_add_u32 v9, 27648, v6
    s_lshl_b32 s44, s28, 13
    s_mov_b32 m0, s44
    s_add_u32 s40, s68, 40960
    s_mov_b32 s41, 10375168
    s_waitcnt lgkmcnt(0)
    buffer_load_dwordx4 v6, s[16:19], s68 offen offset:0 lds
    buffer_load_dwordx4 v7, s[16:19], s68 offen offset:1024 lds
    buffer_load_dwordx4 v8, s[16:19], s68 offen offset:2048 lds
    buffer_load_dwordx4 v9, s[16:19], s68 offen offset:3072 lds
    s_add_u32 m0, s44, 4096
    s_load_dword s96, s[24:25], s41
    buffer_load_dwordx4 v6, s[16:19], s40 offen offset:0 lds
    buffer_load_dwordx4 v7, s[16:19], s40 offen offset:1024 lds
    buffer_load_dwordx4 v8, s[16:19], s40 offen offset:2048 lds
    buffer_load_dwordx4 v9, s[16:19], s40 offen offset:3072 lds
    s_mov_b32 s22, 2621440
    s_mov_b32 s23, 0x00020000
    s_mov_b32 s26, 268435456
    s_mov_b32 s27, 0x00020000
    v_mov_b32 v30, 0
    s_and_b32 s45, s30, 7
    s_lshr_b32 s39, s30, 3
    s_add_u32 s39, s39, s45
    s_add_u32 s39, s39, 1
    s_and_b32 s39, s39, 3
    s_lshl_b32 s35, s29, 2
    s_add_u32 s35, s35, s39
    v_lshlrev_b32 v41, 4, v1
    v_add_u32 v42, 49152, v41
    v_add_u32 v43, 98304, v41
    v_add_u32 v44, 147456, v41
    v_add_u32 v45, 196608, v41
    s_lshl_b32 s39, s35, 2
    s_add_u32 s39, s39, s28
    s_lshl_b32 s63, s39, 7
    s_add_u32 s63, s63, 10354688
    s_mul_i32 s39, s45, 5
    s_lshr_b32 s39, s39, 2
    s_lshl_b32 s39, s39, 9
    s_mul_i32 s40, s29, 5120
    s_add_u32 s39, s39, s40
    s_lshl_b32 s40, s28, 7
    s_add_u32 s39, s39, s40
    s_add_u32 s64, s39, 10485760
    v_and_b32 v4, 7, v1
    v_min_u32 v4, 5, v4
    v_bfe_u32 v5, v1, 3, 1
    v_lshlrev_b32 v5, 9, v5
    v_lshl_add_u32 v48, v4, 2, v5
    s_lshr_b32 s39, s45, 2
    s_lshl_b32 s39, s39, 1
    s_mul_i32 s40, s35, 24576
    s_mul_i32 s41, s28, 6144
    s_add_u32 s40, s40, s41
    s_mul_i32 s58, s45, 245760
    s_add_u32 s41, s41, s58
    s_add_u32 s41, s41, 8388608
    s_mul_i32 s39, s39, 1536
    s_xor_b32 s58, s39, 3072
    s_add_u32 s50, s39, s40
    s_add_u32 s54, s39, s41
    s_add_u32 s51, s58, s40
    s_add_u32 s55, s58, s41
    s_add_u32 s52, s50, 3145728
    s_add_u32 s56, s54, 24576
    s_add_u32 s53, s51, 3145728
    s_add_u32 s57, s55, 24576
    s_add_u32 s58, s28, s45
    s_and_b32 s58, s58, 3
    s_add_u32 s39, s58, 1
    s_and_b32 s39, s39, 3
    s_mul_i32 s39, s39, 786432
    v_add_u32 v37, s39, v41
    s_add_u32 s39, s58, 2
    s_and_b32 s39, s39, 3
    s_mul_i32 s39, s39, 786432
    v_add_u32 v38, s39, v41
    s_add_u32 s39, s58, 3
    s_and_b32 s39, s39, 3
    s_mul_i32 s39, s39, 786432
    v_add_u32 v39, s39, v41
    s_add_u32 s39, s58, 4
    s_and_b32 s39, s39, 3
    s_mul_i32 s39, s39, 786432
    v_add_u32 v40, s39, v41
    s_mul_i32 s39, s28, 2816
    s_add_u32 s39, s39, 61440
    v_and_b32 v4, 15, v1
    v_lshrrev_b32 v5, 4, v1
    v_mul_u32_u24 v4, 176, v4
    v_lshl_add_u32 v4, v5, 3, v4
    v_add_u32 v46, s39, v4
    v_add_u32 v4, 0, v1
    v_mul_u32_u24 v5, 205, v4
    v_lshrrev_b32 v5, 11, v5
    v_lshlrev_b32 v4, 4, v4
    v_lshl_add_u32 v52, v5, 4, v4
    v_add_u32 v52, s39, v52
    v_mul_u32_u24 v5, 1120, v5
    v_add_u32 v55, v5, v4
    v_add_u32 v4, 64, v1
    v_mul_u32_u24 v5, 205, v4
    v_lshrrev_b32 v5, 11, v5
    v_lshlrev_b32 v4, 4, v4
    v_lshl_add_u32 v53, v5, 4, v4
    v_add_u32 v53, s39, v53
    v_mul_u32_u24 v5, 1120, v5
    v_add_u32 v56, v5, v4
    v_add_u32 v4, 128, v1
    v_min_u32 v4, 159, v4
    v_mul_u32_u24 v5, 205, v4
    v_lshrrev_b32 v5, 11, v5
    v_lshlrev_b32 v4, 4, v4
    v_lshl_add_u32 v54, v5, 4, v4
    v_add_u32 v54, s39, v54
    v_mul_u32_u24 v5, 1120, v5
    v_add_u32 v57, v5, v4
    s_lshl_b32 s39, s35, 2
    s_add_u32 s39, s39, s58
    s_mul_i32 s65, s39, 20480
    s_mul_i32 s40, s45, 160
    s_add_u32 s65, s65, s40
    s_mul_i32 s39, s28, 15360
    v_add_u32 v47, s39, v41
    s_add_u32 s39, s28, 1
    s_and_b32 s39, s39, 3
    s_mul_i32 s39, s39, 15360
    v_add_u32 v34, s39, v41
    s_add_u32 s39, s28, 2
    s_and_b32 s39, s39, 3
    s_mul_i32 s39, s39, 15360
    v_add_u32 v35, s39, v41
    s_add_u32 s39, s28, 3
    s_and_b32 s39, s39, 3
    s_mul_i32 s39, s39, 15360
    v_add_u32 v36, s39, v41
    s_mov_b32 s49, 0
    s_mov_b32 s97, 0
    s_lshl_b32 s98, s2, 2
    s_add_u32 s98, s98, s28
    s_lshl_b32 s39, s45, 2
    s_add_u32 s39, s39, s28
    s_lshr_b32 s40, s29, 1
    s_lshl_b32 s40, s40, 5
    s_add_u32 s40, s40, s39
    s_mul_i32 s42, s40, 20480
    s_add_u32 s42, s42, 1152
    v_and_b32 v2, 15, v1
    v_mul_u32_u24 v2, 1280, v2
    v_lshrrev_b32 v3, 4, v1
    v_lshl_add_u32 v14, v3, 7, v2
    s_mul_i32 s43, s39, 6144
    s_and_b32 s40, s29, 1
    s_mul_i32 s40, s40, 1536
    s_add_u32 s43, s43, s40
    s_add_u32 s43, s43, 1769472
    v_mul_u32_u24 v2, 43, v1
    v_lshrrev_b32 v2, 9, v2
    v_mul_u32_u24 v2, 1536, v2
    v_lshl_add_u32 v15, v1, 7, v2
    v_lshrrev_b32 v3, 2, v1
    v_lshlrev_b32 v3, 7, v3
    v_and_b32 v4, 3, v1
    v_lshl_add_u32 v3, v4, 3, v3
    v_add_u32 v33, s44, v3
    s_mul_i32 s69, s47, 196608
    s_lshl_b32 s39, s46, 10
    s_add_u32 s69, s69, s39
    s_add_u32 s69, s69, 8388608
    s_add_u32 s60, s69, 24576
    s_mul_i32 s39, s46, 43
    s_lshr_b32 s39, s39, 8
    s_mul_i32 s39, s39, 104
    s_lshl_b32 s40, s46, 2
    s_add_u32 s39, s39, s40
    s_lshl_b32 s40, s47, 9
    s_add_u32 s39, s39, s40
    s_add_u32 s39, s39, 10485760
    v_mul_u32_u24 v32, 5120, v1
    v_add_u32 v32, s39, v32
    s_lshl_b32 s39, s98, 2
    s_add_u32 s39, s39, 10368000
    v_writelane_b32 v32, s39, 32
    s_waitcnt lgkmcnt(0)
    s_mul_i32 s70, s96, 0x9E3779B1
    s_add_u32 s70, s70, 0x7F4A7C15
    s_mov_b32 s71, s70
    s_and_b32 s95, s96, 1
    s_lshl_b32 s59, s95, 15
    s_and_b32 s95, s96, 2
    s_lshl_b32 s95, s95, 30
    s_or_b32 s59, s59, s95
    s_and_b32 s95, s96, 4
    s_lshl_b32 s62, s95, 13
    s_and_b32 s95, s96, 8
    s_lshl_b32 s95, s95, 28
    s_or_b32 s62, s62, s95
    s_xor_b32 s99, s59, 0x80008000
    s_xor_b32 s100, s62, 0x80008000
    s_mov_b32 s101, 0
    s_add_u32 s96, s96, 1
    v_mov_b32 v28, s70
    s_waitcnt vmcnt(4)
    ds_read_b64_tr_b16 v[64:65], v33 offset:0
    ds_read_b64_tr_b16 v[66:67], v33 offset:2048
    ds_read_b64_tr_b16 v[68:69], v33 offset:32
    ds_read_b64_tr_b16 v[70:71], v33 offset:2080
    ds_read_b64_tr_b16 v[72:73], v33 offset:64
    ds_read_b64_tr_b16 v[74:75], v33 offset:2112
    ds_read_b64_tr_b16 v[76:77], v33 offset:96
    ds_read_b64_tr_b16 v[78:79], v33 offset:2144
    s_waitcnt lgkmcnt(6)
    v_xor_b32 v64, s59, v64
    v_xor_b32 v65, s62, v65
    v_xor_b32 v66, s99, v66
    v_xor_b32 v67, s100, v67
    buffer_store_dwordx4 v[64:67], v41, s[24:27], s69 offen sc1
    s_waitcnt lgkmcnt(4)
    v_xor_b32 v68, s59, v68
    v_xor_b32 v69, s62, v69
    v_xor_b32 v70, s99, v70
    v_xor_b32 v71, s100, v71
    buffer_store_dwordx4 v[68:71], v42, s[24:27], s69 offen sc1
    s_waitcnt lgkmcnt(2)
    v_xor_b32 v72, s59, v72
    v_xor_b32 v73, s62, v73
    v_xor_b32 v74, s99, v74
    v_xor_b32 v75, s100, v75
    buffer_store_dwordx4 v[72:75], v43, s[24:27], s69 offen sc1
    s_waitcnt lgkmcnt(0)
    v_xor_b32 v76, s59, v76
    v_xor_b32 v77, s62, v77
    v_xor_b32 v78, s99, v78
    v_xor_b32 v79, s100, v79
    buffer_store_dwordx4 v[76:79], v44, s[24:27], s69 offen sc1
    s_waitcnt vmcnt(4)
    ds_read_b64_tr_b16 v[80:81], v33 offset:4096
    ds_read_b64_tr_b16 v[82:83], v33 offset:6144
    ds_read_b64_tr_b16 v[84:85], v33 offset:4128
    ds_read_b64_tr_b16 v[86:87], v33 offset:6176
    ds_read_b64_tr_b16 v[88:89], v33 offset:4160
    ds_read_b64_tr_b16 v[90:91], v33 offset:6208
    ds_read_b64_tr_b16 v[92:93], v33 offset:4192
    ds_read_b64_tr_b16 v[94:95], v33 offset:6240
    s_waitcnt lgkmcnt(6)
    v_xor_b32 v80, s59, v80
    v_xor_b32 v81, s62, v81
    v_xor_b32 v82, s99, v82
    v_xor_b32 v83, s100, v83
    buffer_store_dwordx4 v[80:83], v41, s[24:27], s60 offen sc1
    s_waitcnt lgkmcnt(4)
    v_xor_b32 v84, s59, v84
    v_xor_b32 v85, s62, v85
    v_xor_b32 v86, s99, v86
    v_xor_b32 v87, s100, v87
    buffer_store_dwordx4 v[84:87], v42, s[24:27], s60 offen sc1
    s_waitcnt lgkmcnt(2)
    v_xor_b32 v88, s59, v88
    v_xor_b32 v89, s62, v89
    v_xor_b32 v90, s99, v90
    v_xor_b32 v91, s100, v91
    buffer_store_dwordx4 v[88:91], v43, s[24:27], s60 offen sc1
    s_waitcnt lgkmcnt(0)
    v_xor_b32 v92, s59, v92
    v_xor_b32 v93, s62, v93
    v_xor_b32 v94, s99, v94
    v_xor_b32 v95, s100, v95
    buffer_store_dwordx4 v[92:95], v44, s[24:27], s60 offen sc1
    s_waitcnt vmcnt(0)
    s_mov_b32 exec_hi, 1
    s_mov_b32 exec_lo, 0xff
    buffer_store_dword v28, v32, s[24:27], 0 offen sc1
    s_mov_b64 exec, -1
    s_mov_b64 exec, 0xffff
    buffer_load_dword v29, v14, s[8:11], s42 offen
    s_mov_b32 exec_lo, 0xffffff
    s_mov_b32 exec_hi, 0x0
    buffer_load_dword v29, v15, s[12:15], s43 offen
    s_mov_b64 exec, -1
    s_barrier
L_w2wait:
    s_add_u32 s39, s64, 512
L_pw_spin:
    s_load_dwordx8 s[72:79], s[24:25], s64 glc
    s_load_dwordx8 s[80:87], s[24:25], s39 glc
    s_add_u32 s49, s49, 1
    s_waitcnt lgkmcnt(0)
    s_xor_b64 s[72:73], s[72:73], s[70:71]
    s_xor_b64 s[74:75], s[74:75], s[70:71]
    s_xor_b64 s[76:77], s[76:77], s[70:71]
    s_xor_b64 s[80:81], s[80:81], s[70:71]
    s_xor_b64 s[82:83], s[82:83], s[70:71]
    s_xor_b64 s[84:85], s[84:85], s[70:71]
    s_or_b64 s[72:73], s[72:73], s[74:75]
    s_or_b64 s[72:73], s[72:73], s[76:77]
    s_or_b64 s[72:73], s[72:73], s[80:81]
    s_or_b64 s[72:73], s[72:73], s[82:83]
    s_or_b64 s[72:73], s[72:73], s[84:85]
    s_cbranch_scc0 L_pw_ok
    s_cmp_lt_u32 s49, 0x80000
    s_cbranch_scc1 L_pw_spin
L_pw_ok:
    buffer_load_dwordx4 a[0:3], v41, s[24:27], s54 offen offset:0 sc1
    buffer_load_dwordx4 a[4:7], v42, s[24:27], s54 offen offset:0 sc1
    buffer_load_dwordx4 a[8:11], v43, s[24:27], s54 offen offset:0 sc1
    buffer_load_dwordx4 a[12:15], v44, s[24:27], s54 offen offset:0 sc1
    buffer_load_dwordx4 a[16:19], v45, s[24:27], s54 offen offset:0 sc1
    buffer_load_dwordx4 a[20:23], v41, s[24:27], s54 offen offset:1024 sc1
    buffer_load_dwordx4 a[24:27], v42, s[24:27], s54 offen offset:1024 sc1
    buffer_load_dwordx4 a[28:31], v43, s[24:27], s54 offen offset:1024 sc1
    buffer_load_dwordx4 a[32:35], v44, s[24:27], s54 offen offset:1024 sc1
    buffer_load_dwordx4 a[36:39], v45, s[24:27], s54 offen offset:1024 sc1
    buffer_load_dwordx4 a[40:43], v41, s[24:27], s54 offen offset:2048 sc1
    buffer_load_dwordx4 a[44:47], v42, s[24:27], s54 offen offset:2048 sc1
    buffer_load_dwordx4 a[48:51], v43, s[24:27], s54 offen offset:2048 sc1
    buffer_load_dwordx4 a[52:55], v44, s[24:27], s54 offen offset:2048 sc1
    buffer_load_dwordx4 a[56:59], v45, s[24:27], s54 offen offset:2048 sc1
    buffer_load_dwordx4 a[60:63], v41, s[24:27], s55 offen offset:0 sc1
    buffer_load_dwordx4 a[64:67], v42, s[24:27], s55 offen offset:0 sc1
    buffer_load_dwordx4 a[68:71], v43, s[24:27], s55 offen offset:0 sc1
    buffer_load_dwordx4 a[72:75], v44, s[24:27], s55 offen offset:0 sc1
    buffer_load_dwordx4 a[76:79], v45, s[24:27], s55 offen offset:0 sc1
    buffer_load_dwordx4 a[80:83], v41, s[24:27], s55 offen offset:1024 sc1
    buffer_load_dwordx4 a[84:87], v42, s[24:27], s55 offen offset:1024 sc1
    buffer_load_dwordx4 a[88:91], v43, s[24:27], s55 offen offset:1024 sc1
    buffer_load_dwordx4 a[92:95], v44, s[24:27], s55 offen offset:1024 sc1
    buffer_load_dwordx4 a[96:99], v45, s[24:27], s55 offen offset:1024 sc1
    buffer_load_dwordx4 a[100:103], v41, s[24:27], s55 offen offset:2048 sc1
    buffer_load_dwordx4 a[104:107], v42, s[24:27], s55 offen offset:2048 sc1
    buffer_load_dwordx4 a[108:111], v43, s[24:27], s55 offen offset:2048 sc1
    buffer_load_dwordx4 a[112:115], v44, s[24:27], s55 offen offset:2048 sc1
    buffer_load_dwordx4 a[116:119], v45, s[24:27], s55 offen offset:2048 sc1
    buffer_load_dwordx4 a[120:123], v41, s[24:27], s56 offen offset:0 sc1
    buffer_load_dwordx4 a[124:127], v42, s[24:27], s56 offen offset:0 sc1
    buffer_load_dwordx4 a[128:131], v43, s[24:27], s56 offen offset:0 sc1
    buffer_load_dwordx4 a[132:135], v44, s[24:27], s56 offen offset:0 sc1
    buffer_load_dwordx4 a[136:139], v45, s[24:27], s56 offen offset:0 sc1
    buffer_load_dwordx4 a[140:143], v41, s[24:27], s56 offen offset:1024 sc1
    buffer_load_dwordx4 a[144:147], v42, s[24:27], s56 offen offset:1024 sc1
    buffer_load_dwordx4 a[148:151], v43, s[24:27], s56 offen offset:1024 sc1
    buffer_load_dwordx4 a[152:155], v44, s[24:27], s56 offen offset:1024 sc1
    buffer_load_dwordx4 a[156:159], v45, s[24:27], s56 offen offset:1024 sc1
    buffer_load_dwordx4 a[160:163], v41, s[24:27], s56 offen offset:2048 sc1
    buffer_load_dwordx4 a[164:167], v42, s[24:27], s56 offen offset:2048 sc1
    buffer_load_dwordx4 a[168:171], v43, s[24:27], s56 offen offset:2048 sc1
    buffer_load_dwordx4 a[172:175], v44, s[24:27], s56 offen offset:2048 sc1
    buffer_load_dwordx4 a[176:179], v45, s[24:27], s56 offen offset:2048 sc1
    buffer_load_dwordx4 a[180:183], v41, s[24:27], s57 offen offset:0 sc1
    buffer_load_dwordx4 a[184:187], v42, s[24:27], s57 offen offset:0 sc1
    buffer_load_dwordx4 a[188:191], v43, s[24:27], s57 offen offset:0 sc1
    buffer_load_dwordx4 a[192:195], v44, s[24:27], s57 offen offset:0 sc1
    buffer_load_dwordx4 a[196:199], v45, s[24:27], s57 offen offset:0 sc1
    buffer_load_dwordx4 a[200:203], v41, s[24:27], s57 offen offset:1024 sc1
    buffer_load_dwordx4 a[204:207], v42, s[24:27], s57 offen offset:1024 sc1
    buffer_load_dwordx4 a[208:211], v43, s[24:27], s57 offen offset:1024 sc1
    buffer_load_dwordx4 a[212:215], v44, s[24:27], s57 offen offset:1024 sc1
    buffer_load_dwordx4 a[216:219], v45, s[24:27], s57 offen offset:1024 sc1
    buffer_load_dwordx4 a[220:223], v41, s[24:27], s57 offen offset:2048 sc1
    buffer_load_dwordx4 a[224:227], v42, s[24:27], s57 offen offset:2048 sc1
    buffer_load_dwordx4 a[228:231], v43, s[24:27], s57 offen offset:2048 sc1
    buffer_load_dwordx4 a[232:235], v44, s[24:27], s57 offen offset:2048 sc1
    buffer_load_dwordx4 a[236:239], v45, s[24:27], s57 offen offset:2048 sc1
    s_load_dwordx8 s[72:79], s[24:25], s63 glc
L_join:
L_ph_spin:
    s_waitcnt lgkmcnt(0)
    s_xor_b64 s[72:73], s[72:73], s[70:71]
    s_xor_b64 s[74:75], s[74:75], s[70:71]
    s_xor_b64 s[76:77], s[76:77], s[70:71]
    s_or_b64 s[72:73], s[72:73], s[74:75]
    s_or_b64 s[72:73], s[72:73], s[76:77]
    s_cbranch_scc0 L_ph_ok
    s_load_dwordx8 s[72:79], s[24:25], s63 glc
    s_add_u32 s49, s49, 1
    s_cmp_lt_u32 s49, 0x80000
    s_cbranch_scc1 L_ph_spin
    s_waitcnt lgkmcnt(0)
L_ph_ok:
L_p2:
    v_mov_b32 v58, 0
    buffer_load_dwordx4 v[64:67], v37, s[24:27], s50 offen offset:0 sc1
    buffer_load_dwordx4 v[68:71], v37, s[24:27], s50 offen offset:1024 sc1
    buffer_load_dwordx4 v[72:75], v37, s[24:27], s50 offen offset:2048 sc1
    buffer_load_dwordx4 v[76:79], v37, s[24:27], s51 offen offset:0 sc1
    buffer_load_dwordx4 v[80:83], v37, s[24:27], s51 offen offset:1024 sc1
    buffer_load_dwordx4 v[84:87], v37, s[24:27], s51 offen offset:2048 sc1
    buffer_load_dwordx4 v[88:91], v37, s[24:27], s52 offen offset:0 sc1
    buffer_load_dwordx4 v[92:95], v37, s[24:27], s52 offen offset:1024 sc1
    buffer_load_dwordx4 v[96:99], v37, s[24:27], s52 offen offset:2048 sc1
    buffer_load_dwordx4 v[100:103], v37, s[24:27], s53 offen offset:0 sc1
    buffer_load_dwordx4 v[104:107], v37, s[24:27], s53 offen offset:1024 sc1
    buffer_load_dwordx4 v[108:111], v37, s[24:27], s53 offen offset:2048 sc1
    s_waitcnt vmcnt(11)
    v_mfma_f32_16x16x32_bf16 v[128:131], a[0:3], v[64:67], 0
    buffer_load_dwordx4 v[112:115], v38, s[24:27], s50 offen offset:0 sc1
    v_mfma_f32_16x16x32_bf16 v[132:135], a[4:7], v[64:67], 0
    v_bitop3_b32 v58, v58, v64, s59 bitop3:0xf6
    v_mfma_f32_16x16x32_bf16 v[136:139], a[8:11], v[64:67], 0
    v_bitop3_b32 v58, v58, v65, s62 bitop3:0xf6
    v_mfma_f32_16x16x32_bf16 v[140:143], a[12:15], v[64:67], 0
    v_bitop3_b32 v58, v58, v66, s99 bitop3:0xf6
    v_mfma_f32_16x16x32_bf16 v[144:147], a[16:19], v[64:67], 0
    v_bitop3_b32 v58, v58, v67, s100 bitop3:0xf6
    s_waitcnt vmcnt(11)
    v_mfma_f32_16x16x32_bf16 v[128:131], a[20:23], v[68:71], v[128:131]
    buffer_load_dwordx4 v[116:119], v38, s[24:27], s50 offen offset:1024 sc1
    v_mfma_f32_16x16x32_bf16 v[132:135], a[24:27], v[68:71], v[132:135]
    v_bitop3_b32 v58, v58, v68, s59 bitop3:0xf6
    v_mfma_f32_16x16x32_bf16 v[136:139], a[28:31], v[68:71], v[136:139]
    v_bitop3_b32 v58, v58, v69, s62 bitop3:0xf6
    v_mfma_f32_16x16x32_bf16 v[140:143], a[32:35], v[68:71], v[140:143]
    v_bitop3_b32 v58, v58, v70, s99 bitop3:0xf6
    v_mfma_f32_16x16x32_bf16 v[144:147], a[36:39], v[68:71], v[144:147]
    v_bitop3_b32 v58, v58, v71, s100 bitop3:0xf6
    s_waitcnt vmcnt(11)
    v_mfma_f32_16x16x32_bf16 v[128:131], a[40:43], v[72:75], v[128:131]
    buffer_load_dwordx4 v[120:123], v38, s[24:27], s50 offen offset:2048 sc1
    v_mfma_f32_16x16x32_bf16 v[132:135], a[44:47], v[72:75], v[132:135]
    v_bitop3_b32 v58, v58, v72, s59 bitop3:0xf6
    v_mfma_f32_16x16x32_bf16 v[136:139], a[48:51], v[72:75], v[136:139]
    v_bitop3_b32 v58, v58, v73, s62 bitop3:0xf6
    v_mfma_f32_16x16x32_bf16 v[140:143], a[52:55], v[72:75], v[140:143]
    v_bitop3_b32 v58, v58, v74, s99 bitop3:0xf6
    v_mfma_f32_16x16x32_bf16 v[144:147], a[56:59], v[72:75], v[144:147]
    v_bitop3_b32 v58, v58, v75, s100 bitop3:0xf6
    s_waitcnt vmcnt(11)
    v_mfma_f32_16x16x32_bf16 v[128:131], a[60:63], v[76:79], v[128:131]
    buffer_load_dwordx4 v[124:127], v38, s[24:27], s51 offen offset:0 sc1
    v_mfma_f32_16x16x32_bf16 v[132:135], a[64:67], v[76:79], v[132:135]
    v_bitop3_b32 v58, v58, v76, s59 bitop3:0xf6
    v_mfma_f32_16x16x32_bf16 v[136:139], a[68:71], v[76:79], v[136:139]
    v_bitop3_b32 v58, v58, v77, s62 bitop3:0xf6
    v_mfma_f32_16x16x32_bf16 v[140:143], a[72:75], v[76:79], v[140:143]
    v_bitop3_b32 v58, v58, v78, s99 bitop3:0xf6
    v_mfma_f32_16x16x32_bf16 v[144:147], a[76:79], v[76:79], v[144:147]
    v_bitop3_b32 v58, v58, v79, s100 bitop3:0xf6
    s_waitcnt vmcnt(11)
    v_mfma_f32_16x16x32_bf16 v[128:131], a[80:83], v[80:83], v[128:131]
    buffer_load_dwordx4 v[64:67], v38, s[24:27], s51 offen offset:1024 sc1
    v_mfma_f32_16x16x32_bf16 v[132:135], a[84:87], v[80:83], v[132:135]
    v_bitop3_b32 v58, v58, v80, s59 bitop3:0xf6
    v_mfma_f32_16x16x32_bf16 v[136:139], a[88:91], v[80:83], v[136:139]
    v_bitop3_b32 v58, v58, v81, s62 bitop3:0xf6
    v_mfma_f32_16x16x32_bf16 v[140:143], a[92:95], v[80:83], v[140:143]
    v_bitop3_b32 v58, v58, v82, s99 bitop3:0xf6
    v_mfma_f32_16x16x32_bf16 v[144:147], a[96:99], v[80:83], v[144:147]
    v_bitop3_b32 v58, v58, v83, s100 bitop3:0xf6
    s_waitcnt vmcnt(11)
    v_mfma_f32_16x16x32_bf16 v[128:131], a[100:103], v[84:87], v[128:131]
    buffer_load_dwordx4 v[68:71], v38, s[24:27], s51 offen offset:2048 sc1
    v_mfma_f32_16x16x32_bf16 v[132:135], a[104:107], v[84:87], v[132:135]
    v_bitop3_b32 v58, v58, v84, s59 bitop3:0xf6
    v_mfma_f32_16x16x32_bf16 v[136:139], a[108:111], v[84:87], v[136:139]
    v_bitop3_b32 v58, v58, v85, s62 bitop3:0xf6
    v_mfma_f32_16x16x32_bf16 v[140:143], a[112:115], v[84:87], v[140:143]
    v_bitop3_b32 v58, v58, v86, s99 bitop3:0xf6
    v_mfma_f32_16x16x32_bf16 v[144:147], a[116:119], v[84:87], v[144:147]
    v_bitop3_b32 v58, v58, v87, s100 bitop3:0xf6
    s_waitcnt vmcnt(11)
    v_and_b32 v59, 0x80008000, v58
    v_cmp_ne_u32 vcc, 0, v59
    s_cbranch_vccnz L_restart
    v_mfma_f32_16x16x32_bf16 v[128:131], a[120:123], v[88:91], v[128:131]
    buffer_load_dwordx4 v[72:75], v38, s[24:27], s52 offen offset:0 sc1
    v_mfma_f32_16x16x32_bf16 v[132:135], a[124:127], v[88:91], v[132:135]
    v_bitop3_b32 v58, v58, v88, s59 bitop3:0xf6
    v_mfma_f32_16x16x32_bf16 v[136:139], a[128:131], v[88:91], v[136:139]
    v_bitop3_b32 v58, v58, v89, s62 bitop3:0xf6
    v_mfma_f32_16x16x32_bf16 v[140:143], a[132:135], v[88:91], v[140:143]
    v_bitop3_b32 v58, v58, v90, s99 bitop3:0xf6
    v_mfma_f32_16x16x32_bf16 v[144:147], a[136:139], v[88:91], v[144:147]
    v_bitop3_b32 v58, v58, v91, s100 bitop3:0xf6
    s_waitcnt vmcnt(11)
    v_mfma_f32_16x16x32_bf16 v[128:131], a[140:143], v[92:95], v[128:131]
    buffer_load_dwordx4 v[76:79], v38, s[24:27], s52 offen offset:1024 sc1
    v_mfma_f32_16x16x32_bf16 v[132:135], a[144:147], v[92:95], v[132:135]
    v_bitop3_b32 v58, v58, v92, s59 bitop3:0xf6
    v_mfma_f32_16x16x32_bf16 v[136:139], a[148:151], v[92:95], v[136:139]
    v_bitop3_b32 v58, v58, v93, s62 bitop3:0xf6
    v_mfma_f32_16x16x32_bf16 v[140:143], a[152:155], v[92:95], v[140:143]
    v_bitop3_b32 v58, v58, v94, s99 bitop3:0xf6
    v_mfma_f32_16x16x32_bf16 v[144:147], a[156:159], v[92:95], v[144:147]
    v_bitop3_b32 v58, v58, v95, s100 bitop3:0xf6
    s_waitcnt vmcnt(11)
    v_mfma_f32_16x16x32_bf16 v[128:131], a[160:163], v[96:99], v[128:131]
    buffer_load_dwordx4 v[80:83], v38, s[24:27], s52 offen offset:2048 sc1
    v_mfma_f32_16x16x32_bf16 v[132:135], a[164:167], v[96:99], v[132:135]
    v_bitop3_b32 v58, v58, v96, s59 bitop3:0xf6
    v_mfma_f32_16x16x32_bf16 v[136:139], a[168:171], v[96:99], v[136:139]
    v_bitop3_b32 v58, v58, v97, s62 bitop3:0xf6
    v_mfma_f32_16x16x32_bf16 v[140:143], a[172:175], v[96:99], v[140:143]
    v_bitop3_b32 v58, v58, v98, s99 bitop3:0xf6
    v_mfma_f32_16x16x32_bf16 v[144:147], a[176:179], v[96:99], v[144:147]
    v_bitop3_b32 v58, v58, v99, s100 bitop3:0xf6
    s_waitcnt vmcnt(11)
    v_mfma_f32_16x16x32_bf16 v[128:131], a[180:183], v[100:103], v[128:131]
    buffer_load_dwordx4 v[84:87], v38, s[24:27], s53 offen offset:0 sc1
    v_mfma_f32_16x16x32_bf16 v[132:135], a[184:187], v[100:103], v[132:135]
    v_bitop3_b32 v58, v58, v100, s59 bitop3:0xf6
    v_mfma_f32_16x16x32_bf16 v[136:139], a[188:191], v[100:103], v[136:139]
    v_bitop3_b32 v58, v58, v101, s62 bitop3:0xf6
    v_mfma_f32_16x16x32_bf16 v[140:143], a[192:195], v[100:103], v[140:143]
    v_bitop3_b32 v58, v58, v102, s99 bitop3:0xf6
    v_mfma_f32_16x16x32_bf16 v[144:147], a[196:199], v[100:103], v[144:147]
    v_bitop3_b32 v58, v58, v103, s100 bitop3:0xf6
    s_waitcnt vmcnt(11)
    v_mfma_f32_16x16x32_bf16 v[128:131], a[200:203], v[104:107], v[128:131]
    buffer_load_dwordx4 v[88:91], v38, s[24:27], s53 offen offset:1024 sc1
    v_mfma_f32_16x16x32_bf16 v[132:135], a[204:207], v[104:107], v[132:135]
    v_bitop3_b32 v58, v58, v104, s59 bitop3:0xf6
    v_mfma_f32_16x16x32_bf16 v[136:139], a[208:211], v[104:107], v[136:139]
    v_bitop3_b32 v58, v58, v105, s62 bitop3:0xf6
    v_mfma_f32_16x16x32_bf16 v[140:143], a[212:215], v[104:107], v[140:143]
    v_bitop3_b32 v58, v58, v106, s99 bitop3:0xf6
    v_mfma_f32_16x16x32_bf16 v[144:147], a[216:219], v[104:107], v[144:147]
    v_bitop3_b32 v58, v58, v107, s100 bitop3:0xf6
    s_waitcnt vmcnt(11)
    v_mfma_f32_16x16x32_bf16 v[128:131], a[220:223], v[108:111], v[128:131]
    buffer_load_dwordx4 v[92:95], v38, s[24:27], s53 offen offset:2048 sc1
    v_mfma_f32_16x16x32_bf16 v[132:135], a[224:227], v[108:111], v[132:135]
    v_bitop3_b32 v58, v58, v108, s59 bitop3:0xf6
    v_mfma_f32_16x16x32_bf16 v[136:139], a[228:231], v[108:111], v[136:139]
    v_bitop3_b32 v58, v58, v109, s62 bitop3:0xf6
    v_mfma_f32_16x16x32_bf16 v[140:143], a[232:235], v[108:111], v[140:143]
    v_bitop3_b32 v58, v58, v110, s99 bitop3:0xf6
    v_mfma_f32_16x16x32_bf16 v[144:147], a[236:239], v[108:111], v[144:147]
    v_bitop3_b32 v58, v58, v111, s100 bitop3:0xf6
L_j12:
    s_waitcnt vmcnt(11)
    v_mfma_f32_16x16x32_bf16 v[148:151], a[0:3], v[112:115], 0
    buffer_load_dwordx4 v[96:99], v39, s[24:27], s50 offen offset:0 sc1
    v_mfma_f32_16x16x32_bf16 v[152:155], a[4:7], v[112:115], 0
    v_bitop3_b32 v58, v58, v112, s59 bitop3:0xf6
    v_mfma_f32_16x16x32_bf16 v[156:159], a[8:11], v[112:115], 0
    v_bitop3_b32 v58, v58, v113, s62 bitop3:0xf6
    v_mfma_f32_16x16x32_bf16 v[160:163], a[12:15], v[112:115], 0
    v_bitop3_b32 v58, v58, v114, s99 bitop3:0xf6
    v_mfma_f32_16x16x32_bf16 v[164:167], a[16:19], v[112:115], 0
    v_bitop3_b32 v58, v58, v115, s100 bitop3:0xf6
    s_waitcnt vmcnt(11)
    v_and_b32 v59, 0x80008000, v58
    v_cmp_ne_u32 vcc, 0, v59
    s_cbranch_vccnz L_restart
    v_mfma_f32_16x16x32_bf16 v[148:151], a[20:23], v[116:119], v[148:151]
    buffer_load_dwordx4 v[100:103], v39, s[24:27], s50 offen offset:1024 sc1
    v_mfma_f32_16x16x32_bf16 v[152:155], a[24:27], v[116:119], v[152:155]
    v_bitop3_b32 v58, v58, v116, s59 bitop3:0xf6
    v_bitop3_b32 v58, v58, v117, s62 bitop3:0xf6
    v_mfma_f32_16x16x32_bf16 v[156:159], a[28:31], v[116:119], v[156:159]
    ds_write_b128 v34, v[128:131] offset:0
    v_mfma_f32_16x16x32_bf16 v[160:163], a[32:35], v[116:119], v[160:163]
    v_bitop3_b32 v58, v58, v118, s99 bitop3:0xf6
    v_mfma_f32_16x16x32_bf16 v[164:167], a[36:39], v[116:119], v[164:167]
    v_bitop3_b32 v58, v58, v119, s100 bitop3:0xf6
    s_waitcnt vmcnt(11)
    v_mfma_f32_16x16x32_bf16 v[148:151], a[40:43], v[120:123], v[148:151]
    buffer_load_dwordx4 v[104:107], v39, s[24:27], s50 offen offset:2048 sc1
    v_mfma_f32_16x16x32_bf16 v[152:155], a[44:47], v[120:123], v[152:155]
    v_bitop3_b32 v58, v58, v120, s59 bitop3:0xf6
    v_bitop3_b32 v58, v58, v121, s62 bitop3:0xf6
    v_mfma_f32_16x16x32_bf16 v[156:159], a[48:51], v[120:123], v[156:159]
    ds_write_b128 v34, v[132:135] offset:1024
    v_mfma_f32_16x16x32_bf16 v[160:163], a[52:55], v[120:123], v[160:163]
    v_bitop3_b32 v58, v58, v122, s99 bitop3:0xf6
    v_mfma_f32_16x16x32_bf16 v[164:167], a[56:59], v[120:123], v[164:167]
    v_bitop3_b32 v58, v58, v123, s100 bitop3:0xf6
    s_waitcnt vmcnt(11)
    v_mfma_f32_16x16x32_bf16 v[148:151], a[60:63], v[124:127], v[148:151]
    buffer_load_dwordx4 v[108:111], v39, s[24:27], s51 offen offset:0 sc1
    v_mfma_f32_16x16x32_bf16 v[152:155], a[64:67], v[124:127], v[152:155]
    v_bitop3_b32 v58, v58, v124, s59 bitop3:0xf6
    v_bitop3_b32 v58, v58, v125, s62 bitop3:0xf6
    v_mfma_f32_16x16x32_bf16 v[156:159], a[68:71], v[124:127], v[156:159]
    ds_write_b128 v34, v[136:139] offset:2048
    v_mfma_f32_16x16x32_bf16 v[160:163], a[72:75], v[124:127], v[160:163]
    v_bitop3_b32 v58, v58, v126, s99 bitop3:0xf6
    v_mfma_f32_16x16x32_bf16 v[164:167], a[76:79], v[124:127], v[164:167]
    v_bitop3_b32 v58, v58, v127, s100 bitop3:0xf6
    s_waitcnt vmcnt(11)
    v_mfma_f32_16x16x32_bf16 v[148:151], a[80:83], v[64:67], v[148:151]
    buffer_load_dwordx4 v[112:115], v39, s[24:27], s51 offen offset:1024 sc1
    v_mfma_f32_16x16x32_bf16 v[152:155], a[84:87], v[64:67], v[152:155]
    v_bitop3_b32 v58, v58, v64, s59 bitop3:0xf6
    v_bitop3_b32 v58, v58, v65, s62 bitop3:0xf6
    v_mfma_f32_16x16x32_bf16 v[156:159], a[88:91], v[64:67], v[156:159]
    ds_write_b128 v34, v[140:143] offset:3072
    v_mfma_f32_16x16x32_bf16 v[160:163], a[92:95], v[64:67], v[160:163]
    v_bitop3_b32 v58, v58, v66, s99 bitop3:0xf6
    v_mfma_f32_16x16x32_bf16 v[164:167], a[96:99], v[64:67], v[164:167]
    v_bitop3_b32 v58, v58, v67, s100 bitop3:0xf6
    s_waitcnt vmcnt(11)
    v_mfma_f32_16x16x32_bf16 v[148:151], a[100:103], v[68:71], v[148:151]
    buffer_load_dwordx4 v[116:119], v39, s[24:27], s51 offen offset:2048 sc1
    v_mfma_f32_16x16x32_bf16 v[152:155], a[104:107], v[68:71], v[152:155]
    v_bitop3_b32 v58, v58, v68, s59 bitop3:0xf6
    v_bitop3_b32 v58, v58, v69, s62 bitop3:0xf6
    v_mfma_f32_16x16x32_bf16 v[156:159], a[108:111], v[68:71], v[156:159]
    ds_write_b128 v34, v[144:147] offset:4096
    v_mfma_f32_16x16x32_bf16 v[160:163], a[112:115], v[68:71], v[160:163]
    v_bitop3_b32 v58, v58, v70, s99 bitop3:0xf6
    v_mfma_f32_16x16x32_bf16 v[164:167], a[116:119], v[68:71], v[164:167]
    v_bitop3_b32 v58, v58, v71, s100 bitop3:0xf6
    s_waitcnt vmcnt(11)
    v_mfma_f32_16x16x32_bf16 v[148:151], a[120:123], v[72:75], v[148:151]
    buffer_load_dwordx4 v[120:123], v39, s[24:27], s52 offen offset:0 sc1
    v_mfma_f32_16x16x32_bf16 v[152:155], a[124:127], v[72:75], v[152:155]
    v_bitop3_b32 v58, v58, v72, s59 bitop3:0xf6
    v_mfma_f32_16x16x32_bf16 v[156:159], a[128:131], v[72:75], v[156:159]
    v_bitop3_b32 v58, v58, v73, s62 bitop3:0xf6
    v_mfma_f32_16x16x32_bf16 v[160:163], a[132:135], v[72:75], v[160:163]
    v_bitop3_b32 v58, v58, v74, s99 bitop3:0xf6
    v_mfma_f32_16x16x32_bf16 v[164:167], a[136:139], v[72:75], v[164:167]
    v_bitop3_b32 v58, v58, v75, s100 bitop3:0xf6
    s_waitcnt vmcnt(11)
    v_mfma_f32_16x16x32_bf16 v[148:151], a[140:143], v[76:79], v[148:151]
    buffer_load_dwordx4 v[124:127], v39, s[24:27], s52 offen offset:1024 sc1
    v_mfma_f32_16x16x32_bf16 v[152:155], a[144:147], v[76:79], v[152:155]
    v_bitop3_b32 v58, v58, v76, s59 bitop3:0xf6
    v_mfma_f32_16x16x32_bf16 v[156:159], a[148:151], v[76:79], v[156:159]
    v_bitop3_b32 v58, v58, v77, s62 bitop3:0xf6
    v_mfma_f32_16x16x32_bf16 v[160:163], a[152:155], v[76:79], v[160:163]
    v_bitop3_b32 v58, v58, v78, s99 bitop3:0xf6
    v_mfma_f32_16x16x32_bf16 v[164:167], a[156:159], v[76:79], v[164:167]
    v_bitop3_b32 v58, v58, v79, s100 bitop3:0xf6
    s_waitcnt vmcnt(11)
    v_mfma_f32_16x16x32_bf16 v[148:151], a[160:163], v[80:83], v[148:151]
    buffer_load_dwordx4 v[64:67], v39, s[24:27], s52 offen offset:2048 sc1
    v_mfma_f32_16x16x32_bf16 v[152:155], a[164:167], v[80:83], v[152:155]
    v_bitop3_b32 v58, v58, v80, s59 bitop3:0xf6
    v_mfma_f32_16x16x32_bf16 v[156:159], a[168:171], v[80:83], v[156:159]
    v_bitop3_b32 v58, v58, v81, s62 bitop3:0xf6
    v_mfma_f32_16x16x32_bf16 v[160:163], a[172:175], v[80:83], v[160:163]
    v_bitop3_b32 v58, v58, v82, s99 bitop3:0xf6
    v_mfma_f32_16x16x32_bf16 v[164:167], a[176:179], v[80:83], v[164:167]
    v_bitop3_b32 v58, v58, v83, s100 bitop3:0xf6
    s_waitcnt vmcnt(11)
    v_mfma_f32_16x16x32_bf16 v[148:151], a[180:183], v[84:87], v[148:151]
    buffer_load_dwordx4 v[68:71], v39, s[24:27], s53 offen offset:0 sc1
    v_mfma_f32_16x16x32_bf16 v[152:155], a[184:187], v[84:87], v[152:155]
    v_bitop3_b32 v58, v58, v84, s59 bitop3:0xf6
    v_mfma_f32_16x16x32_bf16 v[156:159], a[188:191], v[84:87], v[156:159]
    v_bitop3_b32 v58, v58, v85, s62 bitop3:0xf6
    v_mfma_f32_16x16x32_bf16 v[160:163], a[192:195], v[84:87], v[160:163]
    v_bitop3_b32 v58, v58, v86, s99 bitop3:0xf6
    v_mfma_f32_16x16x32_bf16 v[164:167], a[196:199], v[84:87], v[164:167]
    v_bitop3_b32 v58, v58, v87, s100 bitop3:0xf6
    s_waitcnt vmcnt(11)
    v_mfma_f32_16x16x32_bf16 v[148:151], a[200:203], v[88:91], v[148:151]
    buffer_load_dwordx4 v[72:75], v39, s[24:27], s53 offen offset:1024 sc1
    v_mfma_f32_16x16x32_bf16 v[152:155], a[204:207], v[88:91], v[152:155]
    v_bitop3_b32 v58, v58, v88, s59 bitop3:0xf6
    v_mfma_f32_16x16x32_bf16 v[156:159], a[208:211], v[88:91], v[156:159]
    v_bitop3_b32 v58, v58, v89, s62 bitop3:0xf6
    v_mfma_f32_16x16x32_bf16 v[160:163], a[212:215], v[88:91], v[160:163]
    v_bitop3_b32 v58, v58, v90, s99 bitop3:0xf6
    v_mfma_f32_16x16x32_bf16 v[164:167], a[216:219], v[88:91], v[164:167]
    v_bitop3_b32 v58, v58, v91, s100 bitop3:0xf6
    s_waitcnt vmcnt(11)
    v_mfma_f32_16x16x32_bf16 v[148:151], a[220:223], v[92:95], v[148:151]
    buffer_load_dwordx4 v[76:79], v39, s[24:27], s53 offen offset:2048 sc1
    v_mfma_f32_16x16x32_bf16 v[152:155], a[224:227], v[92:95], v[152:155]
    v_bitop3_b32 v58, v58, v92, s59 bitop3:0xf6
    v_mfma_f32_16x16x32_bf16 v[156:159], a[228:231], v[92:95], v[156:159]
    v_bitop3_b32 v58, v58, v93, s62 bitop3:0xf6
    v_mfma_f32_16x16x32_bf16 v[160:163], a[232:235], v[92:95], v[160:163]
    v_bitop3_b32 v58, v58, v94, s99 bitop3:0xf6
    v_mfma_f32_16x16x32_bf16 v[164:167], a[236:239], v[92:95], v[164:167]
    v_bitop3_b32 v58, v58, v95, s100 bitop3:0xf6
    s_waitcnt vmcnt(11)
    v_mfma_f32_16x16x32_bf16 v[168:171], a[0:3], v[96:99], 0
    buffer_load_dwordx4 v[80:83], v40, s[24:27], s50 offen offset:0 sc1
    v_mfma_f32_16x16x32_bf16 v[172:175], a[4:7], v[96:99], 0
    v_bitop3_b32 v58, v58, v96, s59 bitop3:0xf6
    v_mfma_f32_16x16x32_bf16 v[176:179], a[8:11], v[96:99], 0
    v_bitop3_b32 v58, v58, v97, s62 bitop3:0xf6
    v_mfma_f32_16x16x32_bf16 v[180:183], a[12:15], v[96:99], 0
    v_bitop3_b32 v58, v58, v98, s99 bitop3:0xf6
    v_mfma_f32_16x16x32_bf16 v[184:187], a[16:19], v[96:99], 0
    v_bitop3_b32 v58, v58, v99, s100 bitop3:0xf6
    s_waitcnt vmcnt(11)
    v_and_b32 v59, 0x80008000, v58
    v_cmp_ne_u32 vcc, 0, v59
    s_cbranch_vccnz L_restart
    v_mfma_f32_16x16x32_bf16 v[168:171], a[20:23], v[100:103], v[168:171]
    buffer_load_dwordx4 v[84:87], v40, s[24:27], s50 offen offset:1024 sc1
    v_mfma_f32_16x16x32_bf16 v[172:175], a[24:27], v[100:103], v[172:175]
    v_bitop3_b32 v58, v58, v100, s59 bitop3:0xf6
    v_bitop3_b32 v58, v58, v101, s62 bitop3:0xf6
    v_mfma_f32_16x16x32_bf16 v[176:179], a[28:31], v[100:103], v[176:179]
    ds_write_b128 v35, v[148:151] offset:5120
    v_mfma_f32_16x16x32_bf16 v[180:183], a[32:35], v[100:103], v[180:183]
    v_bitop3_b32 v58, v58, v102, s99 bitop3:0xf6
    v_mfma_f32_16x16x32_bf16 v[184:187], a[36:39], v[100:103], v[184:187]
    v_bitop3_b32 v58, v58, v103, s100 bitop3:0xf6
    s_waitcnt vmcnt(11)
    v_mfma_f32_16x16x32_bf16 v[168:171], a[40:43], v[104:107], v[168:171]
    buffer_load_dwordx4 v[88:91], v40, s[24:27], s50 offen offset:2048 sc1
    v_mfma_f32_16x16x32_bf16 v[172:175], a[44:47], v[104:107], v[172:175]
    v_bitop3_b32 v58, v58, v104, s59 bitop3:0xf6
    v_bitop3_b32 v58, v58, v105, s62 bitop3:0xf6
    v_mfma_f32_16x16x32_bf16 v[176:179], a[48:51], v[104:107], v[176:179]
    ds_write_b128 v35, v[152:155] offset:6144
    v_mfma_f32_16x16x32_bf16 v[180:183], a[52:55], v[104:107], v[180:183]
    v_bitop3_b32 v58, v58, v106, s99 bitop3:0xf6
    v_mfma_f32_16x16x32_bf16 v[184:187], a[56:59], v[104:107], v[184:187]
    v_bitop3_b32 v58, v58, v107, s100 bitop3:0xf6
    s_waitcnt vmcnt(11)
    v_mfma_f32_16x16x32_bf16 v[168:171], a[60:63], v[108:111], v[168:171]
    buffer_load_dwordx4 v[92:95], v40, s[24:27], s51 offen offset:0 sc1
    v_mfma_f32_16x16x32_bf16 v[172:175], a[64:67], v[108:111], v[172:175]
    v_bitop3_b32 v58, v58, v108, s59 bitop3:0xf6
    v_bitop3_b32 v58, v58, v109, s62 bitop3:0xf6
    v_mfma_f32_16x16x32_bf16 v[176:179], a[68:71], v[108:111], v[176:179]
    ds_write_b128 v35, v[156:159] offset:7168
    v_mfma_f32_16x16x32_bf16 v[180:183], a[72:75], v[108:111], v[180:183]
    v_bitop3_b32 v58, v58, v110, s99 bitop3:0xf6
    v_mfma_f32_16x16x32_bf16 v[184:187], a[76:79], v[108:111], v[184:187]
    v_bitop3_b32 v58, v58, v111, s100 bitop3:0xf6
    s_waitcnt vmcnt(11)
    v_mfma_f32_16x16x32_bf16 v[168:171], a[80:83], v[112:115], v[168:171]
    buffer_load_dwordx4 v[96:99], v40, s[24:27], s51 offen offset:1024 sc1
    v_mfma_f32_16x16x32_bf16 v[172:175], a[84:87], v[112:115], v[172:175]
    v_bitop3_b32 v58, v58, v112, s59 bitop3:0xf6
    v_bitop3_b32 v58, v58, v113, s62 bitop3:0xf6
    v_mfma_f32_16x16x32_bf16 v[176:179], a[88:91], v[112:115], v[176:179]
    ds_write_b128 v35, v[160:163] offset:8192
    v_mfma_f32_16x16x32_bf16 v[180:183], a[92:95], v[112:115], v[180:183]
    v_bitop3_b32 v58, v58, v114, s99 bitop3:0xf6
    v_mfma_f32_16x16x32_bf16 v[184:187], a[96:99], v[112:115], v[184:187]
    v_bitop3_b32 v58, v58, v115, s100 bitop3:0xf6
    s_waitcnt vmcnt(11)
    v_mfma_f32_16x16x32_bf16 v[168:171], a[100:103], v[116:119], v[168:171]
    buffer_load_dwordx4 v[100:103], v40, s[24:27], s51 offen offset:2048 sc1
    v_mfma_f32_16x16x32_bf16 v[172:175], a[104:107], v[116:119], v[172:175]
    v_bitop3_b32 v58, v58, v116, s59 bitop3:0xf6
    v_bitop3_b32 v58, v58, v117, s62 bitop3:0xf6
    v_mfma_f32_16x16x32_bf16 v[176:179], a[108:111], v[116:119], v[176:179]
    ds_write_b128 v35, v[164:167] offset:9216
    v_mfma_f32_16x16x32_bf16 v[180:183], a[112:115], v[116:119], v[180:183]
    v_bitop3_b32 v58, v58, v118, s99 bitop3:0xf6
    v_mfma_f32_16x16x32_bf16 v[184:187], a[116:119], v[116:119], v[184:187]
    v_bitop3_b32 v58, v58, v119, s100 bitop3:0xf6
    s_waitcnt vmcnt(11)
    v_mfma_f32_16x16x32_bf16 v[168:171], a[120:123], v[120:123], v[168:171]
    buffer_load_dwordx4 v[104:107], v40, s[24:27], s52 offen offset:0 sc1
    v_mfma_f32_16x16x32_bf16 v[172:175], a[124:127], v[120:123], v[172:175]
    v_bitop3_b32 v58, v58, v120, s59 bitop3:0xf6
    v_mfma_f32_16x16x32_bf16 v[176:179], a[128:131], v[120:123], v[176:179]
    v_bitop3_b32 v58, v58, v121, s62 bitop3:0xf6
    v_mfma_f32_16x16x32_bf16 v[180:183], a[132:135], v[120:123], v[180:183]
    v_bitop3_b32 v58, v58, v122, s99 bitop3:0xf6
    v_mfma_f32_16x16x32_bf16 v[184:187], a[136:139], v[120:123], v[184:187]
    v_bitop3_b32 v58, v58, v123, s100 bitop3:0xf6
    s_waitcnt vmcnt(11)
    v_mfma_f32_16x16x32_bf16 v[168:171], a[140:143], v[124:127], v[168:171]
    buffer_load_dwordx4 v[108:111], v40, s[24:27], s52 offen offset:1024 sc1
    v_mfma_f32_16x16x32_bf16 v[172:175], a[144:147], v[124:127], v[172:175]
    v_bitop3_b32 v58, v58, v124, s59 bitop3:0xf6
    v_mfma_f32_16x16x32_bf16 v[176:179], a[148:151], v[124:127], v[176:179]
    v_bitop3_b32 v58, v58, v125, s62 bitop3:0xf6
    v_mfma_f32_16x16x32_bf16 v[180:183], a[152:155], v[124:127], v[180:183]
    v_bitop3_b32 v58, v58, v126, s99 bitop3:0xf6
    v_mfma_f32_16x16x32_bf16 v[184:187], a[156:159], v[124:127], v[184:187]
    v_bitop3_b32 v58, v58, v127, s100 bitop3:0xf6
    s_waitcnt vmcnt(11)
    v_mfma_f32_16x16x32_bf16 v[168:171], a[160:163], v[64:67], v[168:171]
    buffer_load_dwordx4 v[112:115], v40, s[24:27], s52 offen offset:2048 sc1
    v_mfma_f32_16x16x32_bf16 v[172:175], a[164:167], v[64:67], v[172:175]
    v_bitop3_b32 v58, v58, v64, s59 bitop3:0xf6
    v_mfma_f32_16x16x32_bf16 v[176:179], a[168:171], v[64:67], v[176:179]
    v_bitop3_b32 v58, v58, v65, s62 bitop3:0xf6
    v_mfma_f32_16x16x32_bf16 v[180:183], a[172:175], v[64:67], v[180:183]
    v_bitop3_b32 v58, v58, v66, s99 bitop3:0xf6
    v_mfma_f32_16x16x32_bf16 v[184:187], a[176:179], v[64:67], v[184:187]
    v_bitop3_b32 v58, v58, v67, s100 bitop3:0xf6
    s_waitcnt vmcnt(11)
    v_mfma_f32_16x16x32_bf16 v[168:171], a[180:183], v[68:71], v[168:171]
    buffer_load_dwordx4 v[116:119], v40, s[24:27], s53 offen offset:0 sc1
    v_mfma_f32_16x16x32_bf16 v[172:175], a[184:187], v[68:71], v[172:175]
    v_bitop3_b32 v58, v58, v68, s59 bitop3:0xf6
    v_mfma_f32_16x16x32_bf16 v[176:179], a[188:191], v[68:71], v[176:179]
    v_bitop3_b32 v58, v58, v69, s62 bitop3:0xf6
    v_mfma_f32_16x16x32_bf16 v[180:183], a[192:195], v[68:71], v[180:183]
    v_bitop3_b32 v58, v58, v70, s99 bitop3:0xf6
    v_mfma_f32_16x16x32_bf16 v[184:187], a[196:199], v[68:71], v[184:187]
    v_bitop3_b32 v58, v58, v71, s100 bitop3:0xf6
    s_waitcnt vmcnt(11)
    v_mfma_f32_16x16x32_bf16 v[168:171], a[200:203], v[72:75], v[168:171]
    buffer_load_dwordx4 v[120:123], v40, s[24:27], s53 offen offset:1024 sc1
    v_mfma_f32_16x16x32_bf16 v[172:175], a[204:207], v[72:75], v[172:175]
    v_bitop3_b32 v58, v58, v72, s59 bitop3:0xf6
    v_mfma_f32_16x16x32_bf16 v[176:179], a[208:211], v[72:75], v[176:179]
    v_bitop3_b32 v58, v58, v73, s62 bitop3:0xf6
    v_mfma_f32_16x16x32_bf16 v[180:183], a[212:215], v[72:75], v[180:183]
    v_bitop3_b32 v58, v58, v74, s99 bitop3:0xf6
    v_mfma_f32_16x16x32_bf16 v[184:187], a[216:219], v[72:75], v[184:187]
    v_bitop3_b32 v58, v58, v75, s100 bitop3:0xf6
    s_waitcnt vmcnt(11)
    v_mfma_f32_16x16x32_bf16 v[168:171], a[220:223], v[76:79], v[168:171]
    buffer_load_dwordx4 v[124:127], v40, s[24:27], s53 offen offset:2048 sc1
    v_mfma_f32_16x16x32_bf16 v[172:175], a[224:227], v[76:79], v[172:175]
    v_bitop3_b32 v58, v58, v76, s59 bitop3:0xf6
    v_mfma_f32_16x16x32_bf16 v[176:179], a[228:231], v[76:79], v[176:179]
    v_bitop3_b32 v58, v58, v77, s62 bitop3:0xf6
    v_mfma_f32_16x16x32_bf16 v[180:183], a[232:235], v[76:79], v[180:183]
    v_bitop3_b32 v58, v58, v78, s99 bitop3:0xf6
    v_mfma_f32_16x16x32_bf16 v[184:187], a[236:239], v[76:79], v[184:187]
    v_bitop3_b32 v58, v58, v79, s100 bitop3:0xf6
    s_waitcnt vmcnt(11)
    v_mfma_f32_16x16x32_bf16 v[188:191], a[0:3], v[80:83], 0
    v_bitop3_b32 v58, v58, v80, s59 bitop3:0xf6
    v_bitop3_b32 v58, v58, v83, s100 bitop3:0xf6
    v_mfma_f32_16x16x32_bf16 v[192:195], a[4:7], v[80:83], 0
    v_bitop3_b32 v58, v58, v81, s62 bitop3:0xf6
    v_mfma_f32_16x16x32_bf16 v[196:199], a[8:11], v[80:83], 0
    v_bitop3_b32 v58, v58, v82, s99 bitop3:0xf6
    v_mfma_f32_16x16x32_bf16 v[200:203], a[12:15], v[80:83], 0
    ds_write_b128 v36, v[168:171] offset:10240
    v_mfma_f32_16x16x32_bf16 v[204:207], a[16:19], v[80:83], 0
    ds_write_b128 v36, v[172:175] offset:11264
    s_waitcnt vmcnt(10)
    v_mfma_f32_16x16x32_bf16 v[188:191], a[20:23], v[84:87], v[188:191]
    ds_write_b128 v36, v[176:179] offset:12288
    v_mfma_f32_16x16x32_bf16 v[192:195], a[24:27], v[84:87], v[192:195]
    v_bitop3_b32 v58, v58, v84, s59 bitop3:0xf6
    v_bitop3_b32 v58, v58, v86, s99 bitop3:0xf6
    v_mfma_f32_16x16x32_bf16 v[196:199], a[28:31], v[84:87], v[196:199]
    ds_write_b128 v36, v[180:183] offset:13312
    v_mfma_f32_16x16x32_bf16 v[200:203], a[32:35], v[84:87], v[200:203]
    v_bitop3_b32 v58, v58, v85, s62 bitop3:0xf6
    v_bitop3_b32 v58, v58, v87, s100 bitop3:0xf6
    v_mfma_f32_16x16x32_bf16 v[204:207], a[36:39], v[84:87], v[204:207]
    ds_write_b128 v36, v[184:187] offset:14336
    s_waitcnt vmcnt(9)
    v_and_b32 v59, 0x80008000, v58
    v_cmp_ne_u32 vcc, 0, v59
    s_cbranch_vccnz L_restart
    s_waitcnt lgkmcnt(0)
    s_barrier
    v_mfma_f32_16x16x32_bf16 v[188:191], a[40:43], v[88:91], v[188:191]
    ds_read_b128 v[128:131], v47 offset:0
    v_mfma_f32_16x16x32_bf16 v[192:195], a[44:47], v[88:91], v[192:195]
    v_bitop3_b32 v58, v58, v88, s59 bitop3:0xf6
    ds_read_b128 v[148:151], v47 offset:5120
    v_mfma_f32_16x16x32_bf16 v[196:199], a[48:51], v[88:91], v[196:199]
    v_bitop3_b32 v58, v58, v89, s62 bitop3:0xf6
    ds_read_b128 v[168:171], v47 offset:10240
    v_mfma_f32_16x16x32_bf16 v[200:203], a[52:55], v[88:91], v[200:203]
    v_bitop3_b32 v58, v58, v90, s99 bitop3:0xf6
    ds_read_b128 v[132:135], v47 offset:1024
    v_mfma_f32_16x16x32_bf16 v[204:207], a[56:59], v[88:91], v[204:207]
    v_bitop3_b32 v58, v58, v91, s100 bitop3:0xf6
    ds_read_b128 v[152:155], v47 offset:6144
    s_waitcnt vmcnt(8)
    v_mfma_f32_16x16x32_bf16 v[188:191], a[60:63], v[92:95], v[188:191]
    ds_read_b128 v[172:175], v47 offset:11264
    v_mfma_f32_16x16x32_bf16 v[192:195], a[64:67], v[92:95], v[192:195]
    v_bitop3_b32 v58, v58, v92, s59 bitop3:0xf6
    ds_read_b128 v[136:139], v47 offset:2048
    v_mfma_f32_16x16x32_bf16 v[196:199], a[68:71], v[92:95], v[196:199]
    v_bitop3_b32 v58, v58, v93, s62 bitop3:0xf6
    ds_read_b128 v[156:159], v47 offset:7168
    v_mfma_f32_16x16x32_bf16 v[200:203], a[72:75], v[92:95], v[200:203]
    v_bitop3_b32 v58, v58, v94, s99 bitop3:0xf6
    ds_read_b128 v[176:179], v47 offset:12288
    v_mfma_f32_16x16x32_bf16 v[204:207], a[76:79], v[92:95], v[204:207]
    v_bitop3_b32 v58, v58, v95, s100 bitop3:0xf6
    ds_read_b128 v[140:143], v47 offset:3072
    s_waitcnt vmcnt(7)
    v_mfma_f32_16x16x32_bf16 v[188:191], a[80:83], v[96:99], v[188:191]
    ds_read_b128 v[160:163], v47 offset:8192
    v_mfma_f32_16x16x32_bf16 v[192:195], a[84:87], v[96:99], v[192:195]
    v_bitop3_b32 v58, v58, v96, s59 bitop3:0xf6
    ds_read_b128 v[180:183], v47 offset:13312
    v_mfma_f32_16x16x32_bf16 v[196:199], a[88:91], v[96:99], v[196:199]
    v_bitop3_b32 v58, v58, v97, s62 bitop3:0xf6
    ds_read_b128 v[144:147], v47 offset:4096
    v_mfma_f32_16x16x32_bf16 v[200:203], a[92:95], v[96:99], v[200:203]
    v_bitop3_b32 v58, v58, v98, s99 bitop3:0xf6
    ds_read_b128 v[164:167], v47 offset:9216
    v_mfma_f32_16x16x32_bf16 v[204:207], a[96:99], v[96:99], v[204:207]
    v_bitop3_b32 v58, v58, v99, s100 bitop3:0xf6
    ds_read_b128 v[184:187], v47 offset:14336
    s_waitcnt vmcnt(6)
    s_waitcnt lgkmcnt(5)
    v_mfma_f32_16x16x32_bf16 v[188:191], a[100:103], v[100:103], v[188:191]
    v_add_f32 v128, v128, v148
    v_add_f32 v129, v129, v149
    v_mfma_f32_16x16x32_bf16 v[192:195], a[104:107], v[100:103], v[192:195]
    v_bitop3_b32 v58, v58, v100, s59 bitop3:0xf6
    v_add_f32 v130, v130, v150
    v_mfma_f32_16x16x32_bf16 v[196:199], a[108:111], v[100:103], v[196:199]
    v_bitop3_b32 v58, v58, v101, s62 bitop3:0xf6
    v_add_f32 v131, v131, v151
    v_mfma_f32_16x16x32_bf16 v[200:203], a[112:115], v[100:103], v[200:203]
    v_bitop3_b32 v58, v58, v102, s99 bitop3:0xf6
    v_add_f32 v128, v128, v168
    v_mfma_f32_16x16x32_bf16 v[204:207], a[116:119], v[100:103], v[204:207]
    v_bitop3_b32 v58, v58, v103, s100 bitop3:0xf6
    v_add_f32 v129, v129, v169
    s_waitcnt vmcnt(5)
    v_mfma_f32_16x16x32_bf16 v[188:191], a[120:123], v[104:107], v[188:191]
    v_add_f32 v130, v130, v170
    v_add_f32 v131, v131, v171
    v_mfma_f32_16x16x32_bf16 v[192:195], a[124:127], v[104:107], v[192:195]
    v_bitop3_b32 v58, v58, v104, s59 bitop3:0xf6
    v_add_f32 v132, v132, v152
    v_mfma_f32_16x16x32_bf16 v[196:199], a[128:131], v[104:107], v[196:199]
    v_bitop3_b32 v58, v58, v105, s62 bitop3:0xf6
    v_add_f32 v133, v133, v153
    v_mfma_f32_16x16x32_bf16 v[200:203], a[132:135], v[104:107], v[200:203]
    v_bitop3_b32 v58, v58, v106, s99 bitop3:0xf6
    v_add_f32 v134, v134, v154
    v_mfma_f32_16x16x32_bf16 v[204:207], a[136:139], v[104:107], v[204:207]
    v_bitop3_b32 v58, v58, v107, s100 bitop3:0xf6
    v_add_f32 v135, v135, v155
    s_waitcnt vmcnt(4)
    v_mfma_f32_16x16x32_bf16 v[188:191], a[140:143], v[108:111], v[188:191]
    v_add_f32 v132, v132, v172
    v_add_f32 v133, v133, v173
    v_mfma_f32_16x16x32_bf16 v[192:195], a[144:147], v[108:111], v[192:195]
    v_bitop3_b32 v58, v58, v108, s59 bitop3:0xf6
    v_add_f32 v134, v134, v174
    v_mfma_f32_16x16x32_bf16 v[196:199], a[148:151], v[108:111], v[196:199]
    v_bitop3_b32 v58, v58, v109, s62 bitop3:0xf6
    v_add_f32 v135, v135, v175
    v_mfma_f32_16x16x32_bf16 v[200:203], a[152:155], v[108:111], v[200:203]
    v_bitop3_b32 v58, v58, v110, s99 bitop3:0xf6
    v_add_f32 v136, v136, v156
    v_mfma_f32_16x16x32_bf16 v[204:207], a[156:159], v[108:111], v[204:207]
    v_bitop3_b32 v58, v58, v111, s100 bitop3:0xf6
    v_add_f32 v137, v137, v157
    s_waitcnt vmcnt(3)
    v_mfma_f32_16x16x32_bf16 v[188:191], a[160:163], v[112:115], v[188:191]
    v_add_f32 v138, v138, v158
    v_add_f32 v139, v139, v159
    v_mfma_f32_16x16x32_bf16 v[192:195], a[164:167], v[112:115], v[192:195]
    v_bitop3_b32 v58, v58, v112, s59 bitop3:0xf6
    v_add_f32 v136, v136, v176
    v_mfma_f32_16x16x32_bf16 v[196:199], a[168:171], v[112:115], v[196:199]
    v_bitop3_b32 v58, v58, v113, s62 bitop3:0xf6
    v_add_f32 v137, v137, v177
    v_mfma_f32_16x16x32_bf16 v[200:203], a[172:175], v[112:115], v[200:203]
    v_bitop3_b32 v58, v58, v114, s99 bitop3:0xf6
    v_add_f32 v138, v138, v178
    v_mfma_f32_16x16x32_bf16 v[204:207], a[176:179], v[112:115], v[204:207]
    v_bitop3_b32 v58, v58, v115, s100 bitop3:0xf6
    v_add_f32 v139, v139, v179
    s_waitcnt vmcnt(2)
    v_mfma_f32_16x16x32_bf16 v[188:191], a[180:183], v[116:119], v[188:191]
    s_waitcnt lgkmcnt(0)
    v_add_f32 v140, v140, v160
    v_add_f32 v141, v141, v161
    v_mfma_f32_16x16x32_bf16 v[192:195], a[184:187], v[116:119], v[192:195]
    v_bitop3_b32 v58, v58, v116, s59 bitop3:0xf6
    v_add_f32 v142, v142, v162
    v_mfma_f32_16x16x32_bf16 v[196:199], a[188:191], v[116:119], v[196:199]
    v_bitop3_b32 v58, v58, v117, s62 bitop3:0xf6
    v_add_f32 v143, v143, v163
    v_mfma_f32_16x16x32_bf16 v[200:203], a[192:195], v[116:119], v[200:203]
    v_bitop3_b32 v58, v58, v118, s99 bitop3:0xf6
    v_add_f32 v140, v140, v180
    v_mfma_f32_16x16x32_bf16 v[204:207], a[196:199], v[116:119], v[204:207]
    v_bitop3_b32 v58, v58, v119, s100 bitop3:0xf6
    v_add_f32 v141, v141, v181
    s_waitcnt vmcnt(1)
    v_mfma_f32_16x16x32_bf16 v[188:191], a[200:203], v[120:123], v[188:191]
    v_add_f32 v142, v142, v182
    v_add_f32 v143, v143, v183
    v_mfma_f32_16x16x32_bf16 v[192:195], a[204:207], v[120:123], v[192:195]
    v_bitop3_b32 v58, v58, v120, s59 bitop3:0xf6
    v_add_f32 v144, v144, v164
    v_mfma_f32_16x16x32_bf16 v[196:199], a[208:211], v[120:123], v[196:199]
    v_bitop3_b32 v58, v58, v121, s62 bitop3:0xf6
    v_add_f32 v145, v145, v165
    v_mfma_f32_16x16x32_bf16 v[200:203], a[212:215], v[120:123], v[200:203]
    v_bitop3_b32 v58, v58, v122, s99 bitop3:0xf6
    v_add_f32 v146, v146, v166
    v_mfma_f32_16x16x32_bf16 v[204:207], a[216:219], v[120:123], v[204:207]
    v_bitop3_b32 v58, v58, v123, s100 bitop3:0xf6
    v_add_f32 v147, v147, v167
    s_waitcnt vmcnt(0)
    v_mfma_f32_16x16x32_bf16 v[188:191], a[220:223], v[124:127], v[188:191]
    v_add_f32 v144, v144, v184
    v_add_f32 v145, v145, v185
    v_mfma_f32_16x16x32_bf16 v[192:195], a[224:227], v[124:127], v[192:195]
    v_bitop3_b32 v58, v58, v124, s59 bitop3:0xf6
    v_add_f32 v146, v146, v186
    v_mfma_f32_16x16x32_bf16 v[196:199], a[228:231], v[124:127], v[196:199]
    v_bitop3_b32 v58, v58, v125, s62 bitop3:0xf6
    v_add_f32 v147, v147, v187
    v_mfma_f32_16x16x32_bf16 v[200:203], a[232:235], v[124:127], v[200:203]
    v_bitop3_b32 v58, v58, v126, s99 bitop3:0xf6
    v_mfma_f32_16x16x32_bf16 v[204:207], a[236:239], v[124:127], v[204:207]
    v_bitop3_b32 v58, v58, v127, s100 bitop3:0xf6
    v_and_b32 v59, 0x80008000, v58
    v_cmp_ne_u32 vcc, 0, v59
    s_cbranch_vccnz L_redo3
L_fin:
    s_nop 4
    v_add_f32 v128, v128, v188
    v_add_f32 v129, v129, v189
    v_add_f32 v130, v130, v190
    v_add_f32 v131, v131, v191
    v_cvt_pk_bf16_f32 v128, v128, v129
    v_cvt_pk_bf16_f32 v129, v130, v131
    ds_write_b64 v46, v[128:129] offset:0
    v_add_f32 v132, v132, v192
    v_add_f32 v133, v133, v193
    v_add_f32 v134, v134, v194
    v_add_f32 v135, v135, v195
    v_cvt_pk_bf16_f32 v132, v132, v133
    v_cvt_pk_bf16_f32 v133, v134, v135
    ds_write_b64 v46, v[132:133] offset:32
    v_add_f32 v136, v136, v196
    v_add_f32 v137, v137, v197
    v_add_f32 v138, v138, v198
    v_add_f32 v139, v139, v199
    v_cvt_pk_bf16_f32 v136, v136, v137
    v_cvt_pk_bf16_f32 v137, v138, v139
    ds_write_b64 v46, v[136:137] offset:64
    v_add_f32 v140, v140, v200
    v_add_f32 v141, v141, v201
    v_add_f32 v142, v142, v202
    v_add_f32 v143, v143, v203
    v_cvt_pk_bf16_f32 v140, v140, v141
    v_cvt_pk_bf16_f32 v141, v142, v143
    ds_write_b64 v46, v[140:141] offset:96
    v_add_f32 v144, v144, v204
    v_add_f32 v145, v145, v205
    v_add_f32 v146, v146, v206
    v_add_f32 v147, v147, v207
    v_cvt_pk_bf16_f32 v144, v144, v145
    v_cvt_pk_bf16_f32 v145, v146, v147
    ds_write_b64 v46, v[144:145] offset:128
    s_waitcnt lgkmcnt(0)
    ds_read_b128 v[64:67], v52
    ds_read_b128 v[68:71], v53
    ds_read_b128 v[72:75], v54
    s_waitcnt lgkmcnt(2)
    buffer_store_dwordx4 v[64:67], v55, s[20:23], s65 offen
    s_waitcnt lgkmcnt(1)
    buffer_store_dwordx4 v[68:71], v56, s[20:23], s65 offen
    s_waitcnt lgkmcnt(0)
    s_mov_b32 exec_hi, 0
    buffer_store_dwordx4 v[72:75], v57, s[20:23], s65 offen
    s_mov_b64 exec, -1
    s_cmp_lg_u32 s98, 1023
    s_cbranch_scc1 L_noep
L_ep_spin:
    s_mov_b32 s39, 10371072
    s_mov_b32 s40, 10354688
    s_mov_b32 s41, 10362880
    v_lshlrev_b32 v2, 7, v1
    buffer_load_dwordx4 v[224:227], v41, s[24:27], s39 offen sc1
    buffer_load_dwordx4 v[228:231], v2, s[24:27], s40 offen sc1
    buffer_load_dwordx4 v[232:235], v2, s[24:27], s41 offen sc1
    buffer_load_dwordx2 v[236:237], v2, s[24:27], s40 offen offset:16 sc1
    buffer_load_dwordx2 v[238:239], v2, s[24:27], s41 offen offset:16 sc1
    s_add_u32 s49, s49, 1
    s_waitcnt vmcnt(0)
    v_xor_b32 v224, v224, v28
    v_xor_b32 v225, v225, v28
    v_xor_b32 v226, v226, v28
    v_xor_b32 v227, v227, v28
    v_xor_b32 v228, v228, v28
    v_xor_b32 v229, v229, v28
    v_xor_b32 v230, v230, v28
    v_xor_b32 v231, v231, v28
    v_xor_b32 v232, v232, v28
    v_xor_b32 v233, v233, v28
    v_xor_b32 v234, v234, v28
    v_xor_b32 v235, v235, v28
    v_xor_b32 v236, v236, v28
    v_xor_b32 v237, v237, v28
    v_xor_b32 v238, v238, v28
    v_xor_b32 v239, v239, v28
    v_or_b32 v224, v224, v225
    v_or_b32 v224, v224, v226
    v_or_b32 v224, v224, v227
    v_or_b32 v224, v224, v228
    v_or_b32 v224, v224, v229
    v_or_b32 v224, v224, v230
    v_or_b32 v224, v224, v231
    v_or_b32 v224, v224, v232
    v_or_b32 v224, v224, v233
    v_or_b32 v224, v224, v234
    v_or_b32 v224, v224, v235
    v_or_b32 v224, v224, v236
    v_or_b32 v224, v224, v237
    v_or_b32 v224, v224, v238
    v_or_b32 v224, v224, v239
    v_cmp_ne_u32 vcc, 0, v224
    s_cmp_ge_u32 s49, 0x80000
    s_cbranch_scc1 L_ep_done
    s_cbranch_vccnz L_ep_spin
L_ep_done:
    s_mov_b32 s39, 10375168
    v_mov_b32 v224, s96
    s_mov_b64 exec, 1
    buffer_store_dword v224, v30, s[24:27], s39 offen sc1
    s_mov_b64 exec, -1
L_noep:
L_end:
    s_endpgm
L_restart:
    s_waitcnt vmcnt(0) lgkmcnt(0)
    s_add_u32 s101, s101, 1
    s_cmp_lt_u32 s101, 0x10000
    s_cbranch_scc1 L_p2
    s_endpgm
L_redo3:
    s_add_u32 s101, s101, 1
    s_cmp_ge_u32 s101, 0x10000
    s_cbranch_scc1 L_fin
    v_mov_b32 v58, 0
    buffer_load_dwordx4 v[64:67], v40, s[24:27], s50 offen offset:0 sc1
    buffer_load_dwordx4 v[68:71], v40, s[24:27], s50 offen offset:1024 sc1
    buffer_load_dwordx4 v[72:75], v40, s[24:27], s50 offen offset:2048 sc1
    buffer_load_dwordx4 v[76:79], v40, s[24:27], s51 offen offset:0 sc1
    buffer_load_dwordx4 v[80:83], v40, s[24:27], s51 offen offset:1024 sc1
    buffer_load_dwordx4 v[84:87], v40, s[24:27], s51 offen offset:2048 sc1
    buffer_load_dwordx4 v[88:91], v40, s[24:27], s52 offen offset:0 sc1
    buffer_load_dwordx4 v[92:95], v40, s[24:27], s52 offen offset:1024 sc1
    buffer_load_dwordx4 v[96:99], v40, s[24:27], s52 offen offset:2048 sc1
    buffer_load_dwordx4 v[100:103], v40, s[24:27], s53 offen offset:0 sc1
    buffer_load_dwordx4 v[104:107], v40, s[24:27], s53 offen offset:1024 sc1
    buffer_load_dwordx4 v[108:111], v40, s[24:27], s53 offen offset:2048 sc1
    s_waitcnt vmcnt(0)
    v_mfma_f32_16x16x32_bf16 v[188:191], a[0:3], v[64:67], 0
    v_mfma_f32_16x16x32_bf16 v[192:195], a[4:7], v[64:67], 0
    v_bitop3_b32 v58, v58, v64, s59 bitop3:0xf6
    v_mfma_f32_16x16x32_bf16 v[196:199], a[8:11], v[64:67], 0
    v_bitop3_b32 v58, v58, v65, s62 bitop3:0xf6
    v_mfma_f32_16x16x32_bf16 v[200:203], a[12:15], v[64:67], 0
    v_bitop3_b32 v58, v58, v66, s99 bitop3:0xf6
    v_mfma_f32_16x16x32_bf16 v[204:207], a[16:19], v[64:67], 0
    v_bitop3_b32 v58, v58, v67, s100 bitop3:0xf6
    v_mfma_f32_16x16x32_bf16 v[188:191], a[20:23], v[68:71], v[188:191]
    v_mfma_f32_16x16x32_bf16 v[192:195], a[24:27], v[68:71], v[192:195]
    v_bitop3_b32 v58, v58, v68, s59 bitop3:0xf6
    v_mfma_f32_16x16x32_bf16 v[196:199], a[28:31], v[68:71], v[196:199]
    v_bitop3_b32 v58, v58, v69, s62 bitop3:0xf6
    v_mfma_f32_16x16x32_bf16 v[200:203], a[32:35], v[68:71], v[200:203]
    v_bitop3_b32 v58, v58, v70, s99 bitop3:0xf6
    v_mfma_f32_16x16x32_bf16 v[204:207], a[36:39], v[68:71], v[204:207]
    v_bitop3_b32 v58, v58, v71, s100 bitop3:0xf6
    v_mfma_f32_16x16x32_bf16 v[188:191], a[40:43], v[72:75], v[188:191]
    v_mfma_f32_16x16x32_bf16 v[192:195], a[44:47], v[72:75], v[192:195]
    v_bitop3_b32 v58, v58, v72, s59 bitop3:0xf6
    v_mfma_f32_16x16x32_bf16 v[196:199], a[48:51], v[72:75], v[196:199]
    v_bitop3_b32 v58, v58, v73, s62 bitop3:0xf6
    v_mfma_f32_16x16x32_bf16 v[200:203], a[52:55], v[72:75], v[200:203]
    v_bitop3_b32 v58, v58, v74, s99 bitop3:0xf6
    v_mfma_f32_16x16x32_bf16 v[204:207], a[56:59], v[72:75], v[204:207]
    v_bitop3_b32 v58, v58, v75, s100 bitop3:0xf6
    v_mfma_f32_16x16x32_bf16 v[188:191], a[60:63], v[76:79], v[188:191]
    v_mfma_f32_16x16x32_bf16 v[192:195], a[64:67], v[76:79], v[192:195]
    v_bitop3_b32 v58, v58, v76, s59 bitop3:0xf6
    v_mfma_f32_16x16x32_bf16 v[196:199], a[68:71], v[76:79], v[196:199]
    v_bitop3_b32 v58, v58, v77, s62 bitop3:0xf6
    v_mfma_f32_16x16x32_bf16 v[200:203], a[72:75], v[76:79], v[200:203]
    v_bitop3_b32 v58, v58, v78, s99 bitop3:0xf6
    v_mfma_f32_16x16x32_bf16 v[204:207], a[76:79], v[76:79], v[204:207]
    v_bitop3_b32 v58, v58, v79, s100 bitop3:0xf6
    v_mfma_f32_16x16x32_bf16 v[188:191], a[80:83], v[80:83], v[188:191]
    v_mfma_f32_16x16x32_bf16 v[192:195], a[84:87], v[80:83], v[192:195]
    v_bitop3_b32 v58, v58, v80, s59 bitop3:0xf6
    v_mfma_f32_16x16x32_bf16 v[196:199], a[88:91], v[80:83], v[196:199]
    v_bitop3_b32 v58, v58, v81, s62 bitop3:0xf6
    v_mfma_f32_16x16x32_bf16 v[200:203], a[92:95], v[80:83], v[200:203]
    v_bitop3_b32 v58, v58, v82, s99 bitop3:0xf6
    v_mfma_f32_16x16x32_bf16 v[204:207], a[96:99], v[80:83], v[204:207]
    v_bitop3_b32 v58, v58, v83, s100 bitop3:0xf6
    v_mfma_f32_16x16x32_bf16 v[188:191], a[100:103], v[84:87], v[188:191]
    v_mfma_f32_16x16x32_bf16 v[192:195], a[104:107], v[84:87], v[192:195]
    v_bitop3_b32 v58, v58, v84, s59 bitop3:0xf6
    v_mfma_f32_16x16x32_bf16 v[196:199], a[108:111], v[84:87], v[196:199]
    v_bitop3_b32 v58, v58, v85, s62 bitop3:0xf6
    v_mfma_f32_16x16x32_bf16 v[200:203], a[112:115], v[84:87], v[200:203]
    v_bitop3_b32 v58, v58, v86, s99 bitop3:0xf6
    v_mfma_f32_16x16x32_bf16 v[204:207], a[116:119], v[84:87], v[204:207]
    v_bitop3_b32 v58, v58, v87, s100 bitop3:0xf6
    v_mfma_f32_16x16x32_bf16 v[188:191], a[120:123], v[88:91], v[188:191]
    v_mfma_f32_16x16x32_bf16 v[192:195], a[124:127], v[88:91], v[192:195]
    v_bitop3_b32 v58, v58, v88, s59 bitop3:0xf6
    v_mfma_f32_16x16x32_bf16 v[196:199], a[128:131], v[88:91], v[196:199]
    v_bitop3_b32 v58, v58, v89, s62 bitop3:0xf6
    v_mfma_f32_16x16x32_bf16 v[200:203], a[132:135], v[88:91], v[200:203]
    v_bitop3_b32 v58, v58, v90, s99 bitop3:0xf6
    v_mfma_f32_16x16x32_bf16 v[204:207], a[136:139], v[88:91], v[204:207]
    v_bitop3_b32 v58, v58, v91, s100 bitop3:0xf6
    v_mfma_f32_16x16x32_bf16 v[188:191], a[140:143], v[92:95], v[188:191]
    v_mfma_f32_16x16x32_bf16 v[192:195], a[144:147], v[92:95], v[192:195]
    v_bitop3_b32 v58, v58, v92, s59 bitop3:0xf6
    v_mfma_f32_16x16x32_bf16 v[196:199], a[148:151], v[92:95], v[196:199]
    v_bitop3_b32 v58, v58, v93, s62 bitop3:0xf6
    v_mfma_f32_16x16x32_bf16 v[200:203], a[152:155], v[92:95], v[200:203]
    v_bitop3_b32 v58, v58, v94, s99 bitop3:0xf6
    v_mfma_f32_16x16x32_bf16 v[204:207], a[156:159], v[92:95], v[204:207]
    v_bitop3_b32 v58, v58, v95, s100 bitop3:0xf6
    v_mfma_f32_16x16x32_bf16 v[188:191], a[160:163], v[96:99], v[188:191]
    v_mfma_f32_16x16x32_bf16 v[192:195], a[164:167], v[96:99], v[192:195]
    v_bitop3_b32 v58, v58, v96, s59 bitop3:0xf6
    v_mfma_f32_16x16x32_bf16 v[196:199], a[168:171], v[96:99], v[196:199]
    v_bitop3_b32 v58, v58, v97, s62 bitop3:0xf6
    v_mfma_f32_16x16x32_bf16 v[200:203], a[172:175], v[96:99], v[200:203]
    v_bitop3_b32 v58, v58, v98, s99 bitop3:0xf6
    v_mfma_f32_16x16x32_bf16 v[204:207], a[176:179], v[96:99], v[204:207]
    v_bitop3_b32 v58, v58, v99, s100 bitop3:0xf6
    v_mfma_f32_16x16x32_bf16 v[188:191], a[180:183], v[100:103], v[188:191]
    v_mfma_f32_16x16x32_bf16 v[192:195], a[184:187], v[100:103], v[192:195]
    v_bitop3_b32 v58, v58, v100, s59 bitop3:0xf6
    v_mfma_f32_16x16x32_bf16 v[196:199], a[188:191], v[100:103], v[196:199]
    v_bitop3_b32 v58, v58, v101, s62 bitop3:0xf6
    v_mfma_f32_16x16x32_bf16 v[200:203], a[192:195], v[100:103], v[200:203]
    v_bitop3_b32 v58, v58, v102, s99 bitop3:0xf6
    v_mfma_f32_16x16x32_bf16 v[204:207], a[196:199], v[100:103], v[204:207]
    v_bitop3_b32 v58, v58, v103, s100 bitop3:0xf6
    v_mfma_f32_16x16x32_bf16 v[188:191], a[200:203], v[104:107], v[188:191]
    v_mfma_f32_16x16x32_bf16 v[192:195], a[204:207], v[104:107], v[192:195]
    v_bitop3_b32 v58, v58, v104, s59 bitop3:0xf6
    v_mfma_f32_16x16x32_bf16 v[196:199], a[208:211], v[104:107], v[196:199]
    v_bitop3_b32 v58, v58, v105, s62 bitop3:0xf6
    v_mfma_f32_16x16x32_bf16 v[200:203], a[212:215], v[104:107], v[200:203]
    v_bitop3_b32 v58, v58, v106, s99 bitop3:0xf6
    v_mfma_f32_16x16x32_bf16 v[204:207], a[216:219], v[104:107], v[204:207]
    v_bitop3_b32 v58, v58, v107, s100 bitop3:0xf6
    v_mfma_f32_16x16x32_bf16 v[188:191], a[220:223], v[108:111], v[188:191]
    v_mfma_f32_16x16x32_bf16 v[192:195], a[224:227], v[108:111], v[192:195]
    v_bitop3_b32 v58, v58, v108, s59 bitop3:0xf6
    v_mfma_f32_16x16x32_bf16 v[196:199], a[228:231], v[108:111], v[196:199]
    v_bitop3_b32 v58, v58, v109, s62 bitop3:0xf6
    v_mfma_f32_16x16x32_bf16 v[200:203], a[232:235], v[108:111], v[200:203]
    v_bitop3_b32 v58, v58, v110, s99 bitop3:0xf6
    v_mfma_f32_16x16x32_bf16 v[204:207], a[236:239], v[108:111], v[204:207]
    v_bitop3_b32 v58, v58, v111, s100 bitop3:0xf6
    v_and_b32 v59, 0x80008000, v58
    v_cmp_ne_u32 vcc, 0, v59
    s_cbranch_vccnz L_redo3
    s_branch L_fin
.section .rodata,"a"
.p2align 6
.amdhsa_kernel standalone__dense_activation_relu__prompt_kernel
  .amdhsa_next_free_vgpr 512
  .amdhsa_next_free_sgpr 102
  .amdhsa_accum_offset 256
  .amdhsa_group_segment_fixed_size 0
  .amdhsa_kernarg_size 48
  .amdhsa_user_sgpr_count 2
  .amdhsa_user_sgpr_kernarg_segment_ptr 1
  .amdhsa_system_sgpr_workgroup_id_x 1
.end_amdhsa_kernel
```
